```python
import torch

def _softmax(x, axis=-1):
    return torch.softmax(x, dim=axis)
def _gelu(x):
    return torch.nn.functional.gelu(x, approximate="tanh")
def _silu(x):
    return torch.nn.functional.silu(x)
def _sigmoid(x):
    return torch.sigmoid(x)
def _layernorm(x, axis=-1, eps=1e-5):
    m = x.mean(dim=axis, keepdim=True)
    v = x.var(dim=axis, keepdim=True, unbiased=False)
    return (x - m) / torch.sqrt(v + eps)
def _scatter_add(tgt, idx, src, axis=0):
    return tgt.clone().index_add_(axis, idx, src)
def _segment_sum(src, seg, n):
    out = torch.zeros((n,) + src.shape[1:], dtype=src.dtype)
    return out.index_add_(0, seg, src)
def _pad(x, pw):
    flat = tuple(v for pair in reversed(pw) for v in pair)
    return torch.nn.functional.pad(x, flat)

kernel_name = 'parallel_sum__grouped_kv_mqa__dense_activation_squared_relu__prompt'

def setup_inputs():

    _w = (lambda a: (lambda t: t.to(torch.bfloat16) if t.is_floating_point() else t)(torch.as_tensor(a)))
    def _A_setup():
        B, S, D, H = 1, 2048, 640, 32
        Dh = D // H
        return {
            "x": _w((lambda *s: torch.randn(*s, dtype=torch.bfloat16) * 0.05)(B, S, D)),
            "wq": _w((lambda *s: torch.randn(*s, dtype=torch.bfloat16) * 0.2)(D, H * Dh)),
            "wk": _w((lambda *s: torch.randn(*s, dtype=torch.bfloat16) * 0.2)(D, Dh)),
            "wv": _w((lambda *s: torch.randn(*s, dtype=torch.bfloat16) * 0.1)(D, Dh)),
            "wo": _w((lambda *s: torch.randn(*s, dtype=torch.bfloat16) * 0.1)(H * Dh, D)),
        }
    _A_in = _A_setup()

    def _B_setup():
        B, S, D, F = 1, 2048, 640, 1536
        return {
            "x": _w((lambda *s: torch.randn(*s, dtype=torch.bfloat16) * 0.05)(B, S, D)),
            "w1": _w((lambda *s: torch.randn(*s, dtype=torch.bfloat16) * 0.1)(D, F)),
            "b1": _w((lambda *s: torch.randn(*s, dtype=torch.bfloat16) * 0.4)(F)),
            "w2": _w((lambda *s: torch.randn(*s, dtype=torch.bfloat16) * 0.1)(F, D)),
            "b2": _w((lambda *s: torch.randn(*s, dtype=torch.bfloat16) * 12.8)(D)),
        }
    _B_in = _B_setup()

    return {
        "A_x": _A_in["x"],
        "A_wq": _A_in["wq"],
        "A_wk": _A_in["wk"],
        "A_wv": _A_in["wv"],
        "A_wo": _A_in["wo"],
        "B_x": _B_in["x"],
        "B_w1": _B_in["w1"],
        "B_b1": _B_in["b1"],
        "B_w2": _B_in["w2"],
        "B_b2": _B_in["b2"],
    }

def reference(A_x, A_wq, A_wk, A_wv, A_wo, B_x, B_w1, B_b1, B_w2, B_b2):
    def _A_ref(x, wq, wk, wv, wo):
        B, S, D = x.shape
        H = 32
        Dh = D // H
        q = (lambda x, *d: x.permute(*d))((x @ wq).reshape(B, S, H, Dh), 0, 2, 1, 3)
        k = x @ wk
        v = x @ wv
        scores = torch.einsum("bhqd,bkd->bhqk", q, k) * (Dh ** -0.5)
        p = _softmax(scores, axis=-1)
        o = torch.einsum("bhqk,bkd->bhqd", p, v)
        return (lambda x, *d: x.permute(*d))(o, 0, 2, 1, 3).reshape(B, S, H * Dh) @ wo

    def _B_ref(x, w1, b1, w2, b2):
        h = torch.einsum("bsd,df->bsf", x, w1) + b1
        zero = torch.zeros_like(h)
        r = torch.where(h > zero, h, zero)
        h = r * r
        out = torch.einsum("bsf,fd->bsd", h, w2) + b2
        return out

    x = A_x
    xn = _layernorm(x, axis=-1)
    return x + _A_ref(xn, A_wq, A_wk, A_wv, A_wo) + _B_ref(xn, B_w1, B_b1, B_w2, B_b2)
```

```asm
; @launch grid=(512,1,1) block=(512,1,1) lds=81920
.amdgcn_target "amdgcn-amd-amdhsa--gfx950"
.text
.globl parallel_sum__grouped_kv_mqa__dense_activation_squared_relu__prompt_kernel
.p2align 8
.type parallel_sum__grouped_kv_mqa__dense_activation_squared_relu__prompt_kernel,@function
parallel_sum__grouped_kv_mqa__dense_activation_squared_relu__prompt_kernel:
  s_cmp_ge_u32 s2, 512
  s_cbranch_scc1 K_end
  s_load_dwordx16 s[4:19], s[0:1], 0
  s_load_dwordx8 s[20:27], s[0:1], 64
  s_load_dwordx2 s[28:29], s[0:1], 96
  v_and_b32 v1, 63, v0
  v_lshrrev_b32 v4, 6, v0
  v_lshrrev_b32 v2, 5, v1
  v_readfirstlane_b32 s30, v4
  v_and_b32 v3, 31, v1
  s_cmp_ge_u32 s2, 256
  s_cbranch_scc1 ROLE_B
  s_mov_b32 s55, s2
  s_lshr_b32 s53, s55, 6
  s_and_b32 s52, s55, 7
  s_lshl_b32 s52, s52, 3
  s_bfe_u32 s54, s55, 0x30003
  s_add_u32 s52, s52, s54
  s_lshl_b32 s54, s52, 5
  s_lshl_b32 s55, s30, 2
  s_add_u32 s54, s54, s55
  v_lshrrev_b32 v4, 4, v1
  v_add_u32 v4, s54, v4
  v_mul_u32_u24 v4, 1280, v4
  v_and_b32 v5, 15, v1
  v_lshl_add_u32 v4, v5, 4, v4
  s_waitcnt lgkmcnt(0)
  s_mov_b32 s40, s4
  s_mov_b32 s41, s5
  s_mov_b32 s42, 2621440
  s_mov_b32 s43, 0x00020000
  buffer_load_dwordx4 v[16:19], v4, s[40:43], 0 offen offset:0
  buffer_load_dwordx4 v[20:23], v4, s[40:43], 0 offen offset:256
  buffer_load_dwordx4 v[24:27], v4, s[40:43], 0 offen offset:512
  buffer_load_dwordx4 v[28:31], v4, s[40:43], 0 offen offset:768
  buffer_load_dwordx4 v[32:35], v4, s[40:43], 0 offen offset:1024
  s_mov_b32 s32, s28
  s_mov_b32 s33, s29
  s_mov_b32 s34, 15138816
  s_mov_b32 s35, 0x00020000
  s_add_u32 s36, s28, 11862016
  s_addc_u32 s37, s29, 0
  s_mov_b32 s38, 409600
  s_mov_b32 s39, 0x00020000
  s_mov_b32 s44, s28
  s_mov_b32 s45, s29
  s_mov_b32 s46, 15138816
  s_mov_b32 s47, 0x00020000
  s_mov_b32 s48, s28
  s_mov_b32 s49, s29
  s_mov_b32 s50, 15138816
  s_mov_b32 s51, 0x00020000
  v_mov_b32 v6, 0
  v_mov_b32 v7, 0
  v_mov_b32 v8, 0
  v_mov_b32 v9, 0
  v_mov_b32 v10, 0
  v_mov_b32 v11, 0
  v_mov_b32 v12, 0
  v_mov_b32 v13, 0
  v_mov_b32 v14, 0
  v_mov_b32 v15, 0
  s_cmp_lg_u32 s2, 0
  s_cbranch_scc1 A_notag
  s_cmp_lg_u32 s30, 0
  s_cbranch_scc1 A_notag
  s_memrealtime s[62:63]
  s_waitcnt lgkmcnt(0)
  s_or_b32 s62, s62, 1
  v_mov_b32 v6, s62
  v_mov_b32 v7, 0
  s_mov_b64 exec, 1
  global_store_dword v7, v6, s[26:27] sc1
  s_mov_b64 exec, -1
A_notag:
  v_lshlrev_b32 v15, 4, v1
  s_and_b32 s60, s52, 7
  s_cmp_lt_u32 s30, 5
  s_cbranch_scc1 A_nowe
  s_cmp_ge_u32 s53, 2
  s_cbranch_scc1 A_nowe
  s_cmp_eq_u32 s53, 1
  s_cselect_b32 s44, s10, s8
  s_cselect_b32 s45, s11, s9
  s_mov_b32 s46, 25600
  s_mov_b32 s47, 0x00020000
  s_sub_u32 s54, s30, 5
  s_mul_i32 s57, s54, 13
  s_min_u32 s54, s54, 1
  s_add_u32 s57, s57, s54
  s_mul_i32 s54, s60, 5
  s_add_u32 s55, s57, s54
  s_cmp_ge_u32 s55, 40
  s_cselect_b32 s54, 40, 0
  s_sub_u32 s55, s55, s54
  s_mul_i32 s58, s55, 640
  s_add_u32 s54, s58, 640
  buffer_load_dwordx4 v[64:67], v15, s[44:47], s58 offen
  s_cmp_eq_u32 s54, 25600
  s_cselect_b32 s58, 0, s54
  s_add_u32 s54, s58, 640
  buffer_load_dwordx4 v[68:71], v15, s[44:47], s58 offen
  s_cmp_eq_u32 s54, 25600
  s_cselect_b32 s58, 0, s54
  s_add_u32 s54, s58, 640
  buffer_load_dwordx4 v[72:75], v15, s[44:47], s58 offen
  s_cmp_eq_u32 s54, 25600
  s_cselect_b32 s58, 0, s54
  s_add_u32 s54, s58, 640
  buffer_load_dwordx4 v[76:79], v15, s[44:47], s58 offen
  s_cmp_eq_u32 s54, 25600
  s_cselect_b32 s58, 0, s54
  s_add_u32 s54, s58, 640
  buffer_load_dwordx4 v[80:83], v15, s[44:47], s58 offen
  s_cmp_eq_u32 s54, 25600
  s_cselect_b32 s58, 0, s54
  s_add_u32 s54, s58, 640
  buffer_load_dwordx4 v[84:87], v15, s[44:47], s58 offen
  s_cmp_eq_u32 s54, 25600
  s_cselect_b32 s58, 0, s54
  s_add_u32 s54, s58, 640
  buffer_load_dwordx4 v[88:91], v15, s[44:47], s58 offen
  s_cmp_eq_u32 s54, 25600
  s_cselect_b32 s58, 0, s54
  s_add_u32 s54, s58, 640
  buffer_load_dwordx4 v[92:95], v15, s[44:47], s58 offen
  s_cmp_eq_u32 s54, 25600
  s_cselect_b32 s58, 0, s54
  s_add_u32 s54, s58, 640
  buffer_load_dwordx4 v[96:99], v15, s[44:47], s58 offen
  s_cmp_eq_u32 s54, 25600
  s_cselect_b32 s58, 0, s54
  s_add_u32 s54, s58, 640
  buffer_load_dwordx4 v[100:103], v15, s[44:47], s58 offen
  s_cmp_eq_u32 s54, 25600
  s_cselect_b32 s58, 0, s54
  s_add_u32 s54, s58, 640
  buffer_load_dwordx4 v[104:107], v15, s[44:47], s58 offen
  s_cmp_eq_u32 s54, 25600
  s_cselect_b32 s58, 0, s54
  s_add_u32 s54, s58, 640
  buffer_load_dwordx4 v[108:111], v15, s[44:47], s58 offen
  s_cmp_eq_u32 s54, 25600
  s_cselect_b32 s58, 0, s54
  s_add_u32 s54, s58, 640
  buffer_load_dwordx4 v[112:115], v15, s[44:47], s58 offen
  s_cmp_eq_u32 s54, 25600
  s_cselect_b32 s58, 0, s54
  s_add_u32 s54, s58, 640
  buffer_load_dwordx4 v[116:119], v15, s[44:47], s58 offen
  s_cmp_eq_u32 s54, 25600
  s_cselect_b32 s58, 0, s54
A_nowe:
  s_barrier
  s_cmp_ge_u32 s30, 5
  s_cbranch_scc1 A_nq
  s_mov_b32 s44, s6
  s_mov_b32 s45, s7
  s_mov_b32 s46, 819200
  s_mov_b32 s47, 0x00020000
  v_lshrrev_b32 v4, 2, v1
  v_mul_u32_u24 v4, 1280, v4
  v_and_b32 v5, 3, v1
  v_lshl_add_u32 v4, v5, 4, v4
  s_mul_i32 s54, s53, 320
  s_lshl_b32 s55, s30, 6
  s_add_u32 s54, s54, s55
  v_add_u32 v12, s54, v4
  s_mul_i32 s59, s30, 3072
  s_add_u32 s59, s59, 42496
  s_mul_i32 s58, s60, 102400
  s_add_u32 s54, s58, 20480
  buffer_load_dwordx4 v[64:67], v12, s[44:47], s58 offen
  s_cmp_eq_u32 s54, 819200
  s_cselect_b32 s58, 0, s54
  s_add_u32 s54, s58, 20480
  buffer_load_dwordx4 v[68:71], v12, s[44:47], s58 offen
  s_cmp_eq_u32 s54, 819200
  s_cselect_b32 s58, 0, s54
  s_add_u32 s54, s58, 20480
  buffer_load_dwordx4 v[72:75], v12, s[44:47], s58 offen
  s_cmp_eq_u32 s54, 819200
  s_cselect_b32 s58, 0, s54
  s_add_u32 s54, s58, 20480
  buffer_load_dwordx4 v[76:79], v12, s[44:47], s58 offen
  s_cmp_eq_u32 s54, 819200
  s_cselect_b32 s58, 0, s54
  s_add_u32 s54, s58, 20480
  buffer_load_dwordx4 v[80:83], v12, s[44:47], s58 offen
  s_cmp_eq_u32 s54, 819200
  s_cselect_b32 s58, 0, s54
  s_add_u32 s54, s58, 20480
  buffer_load_dwordx4 v[84:87], v12, s[44:47], s58 offen
  s_cmp_eq_u32 s54, 819200
  s_cselect_b32 s58, 0, s54
  s_add_u32 s54, s58, 20480
  buffer_load_dwordx4 v[88:91], v12, s[44:47], s58 offen
  s_cmp_eq_u32 s54, 819200
  s_cselect_b32 s58, 0, s54
  s_add_u32 s54, s58, 20480
  buffer_load_dwordx4 v[92:95], v12, s[44:47], s58 offen
  s_cmp_eq_u32 s54, 819200
  s_cselect_b32 s58, 0, s54
  v_bfe_u32 v4, v1, 2, 2
  v_mul_u32_u24 v5, 8, v2
  v_add_u32 v4, v4, v5
  v_bfe_u32 v5, v1, 4, 1
  v_and_b32 v6, 3, v1
  v_lshlrev_b32 v6, 3, v6
  v_lshl_add_u32 v5, v5, 5, v6
  v_mul_u32_u24 v13, 64, v4
  v_add3_u32 v13, v13, v5, s59
  v_add_u32 v14, 256, v13
  v_add_u32 v11, s59, v15
  s_waitcnt vmcnt(8)
  s_mov_b32 s31, 0
  s_branch A_xok
A_nq:
  s_waitcnt vmcnt(14)
  s_cmp_lt_u32 s53, 2
  s_cbranch_scc1 A_xok2
  s_waitcnt vmcnt(0)
A_xok2:
  v_mov_b32 v4, 0
  global_load_dword v61, v4, s[26:27] sc1
A_xok:
  v_mov_b32 v56, 0x3f803f80
  v_mov_b32 v57, 0x00003f80
  v_mov_b32 v58, 0x3f800000
  v_mov_b32 v36, 0
  v_mov_b32 v37, 0
  v_mov_b32 v38, 0
  v_mov_b32 v39, 0
  v_dot2c_f32_bf16 v36, v16, v56
  v_dot2c_f32_bf16 v38, v16, v16
  v_dot2c_f32_bf16 v37, v17, v56
  v_dot2c_f32_bf16 v39, v17, v17
  v_dot2c_f32_bf16 v36, v18, v56
  v_dot2c_f32_bf16 v38, v18, v18
  v_dot2c_f32_bf16 v37, v19, v56
  v_dot2c_f32_bf16 v39, v19, v19
  v_dot2c_f32_bf16 v36, v20, v56
  v_dot2c_f32_bf16 v38, v20, v20
  v_dot2c_f32_bf16 v37, v21, v56
  v_dot2c_f32_bf16 v39, v21, v21
  v_dot2c_f32_bf16 v36, v22, v56
  v_dot2c_f32_bf16 v38, v22, v22
  v_dot2c_f32_bf16 v37, v23, v56
  v_dot2c_f32_bf16 v39, v23, v23
  v_dot2c_f32_bf16 v36, v24, v56
  v_dot2c_f32_bf16 v38, v24, v24
  v_dot2c_f32_bf16 v37, v25, v56
  v_dot2c_f32_bf16 v39, v25, v25
  v_dot2c_f32_bf16 v36, v26, v56
  v_dot2c_f32_bf16 v38, v26, v26
  v_dot2c_f32_bf16 v37, v27, v56
  v_dot2c_f32_bf16 v39, v27, v27
  v_dot2c_f32_bf16 v36, v28, v56
  v_dot2c_f32_bf16 v38, v28, v28
  v_dot2c_f32_bf16 v37, v29, v56
  v_dot2c_f32_bf16 v39, v29, v29
  v_dot2c_f32_bf16 v36, v30, v56
  v_dot2c_f32_bf16 v38, v30, v30
  v_dot2c_f32_bf16 v37, v31, v56
  v_dot2c_f32_bf16 v39, v31, v31
  v_dot2c_f32_bf16 v36, v32, v56
  v_dot2c_f32_bf16 v38, v32, v32
  v_dot2c_f32_bf16 v37, v33, v56
  v_dot2c_f32_bf16 v39, v33, v33
  v_dot2c_f32_bf16 v36, v34, v56
  v_dot2c_f32_bf16 v38, v34, v34
  v_dot2c_f32_bf16 v37, v35, v56
  v_dot2c_f32_bf16 v39, v35, v35
  v_lshrrev_b32 v4, 4, v1
  s_lshl_b32 s54, s30, 2
  v_add_u32 v4, s54, v4
  v_and_b32 v5, 1, v1
  v_mul_u32_u24 v5, 528, v5
  v_lshl_add_u32 v5, v4, 4, v5
  v_add_f32 v52, v36, v37
  v_add_f32 v53, v38, v39
  v_bfe_u32 v6, v1, 1, 3
  s_mul_i32 s54, s60, 5
  s_sub_u32 s54, 40, s54
  v_add_f32_dpp v52, v52, v52 row_ror:8 row_mask:0xf bank_mask:0xf
  v_add_f32_dpp v53, v53, v53 row_ror:8 row_mask:0xf bank_mask:0xf
  s_nop 0
  v_add_f32_dpp v52, v52, v52 row_ror:4 row_mask:0xf bank_mask:0xf
  v_add_f32_dpp v53, v53, v53 row_ror:4 row_mask:0xf bank_mask:0xf
  s_nop 0
  v_add_f32_dpp v52, v52, v52 row_ror:2 row_mask:0xf bank_mask:0xf
  v_add_f32_dpp v53, v53, v53 row_ror:2 row_mask:0xf bank_mask:0xf
  s_nop 0
  v_add_f32_dpp v52, v52, v52 row_ror:1 row_mask:0xf bank_mask:0xf
  v_add_f32_dpp v53, v53, v53 row_ror:1 row_mask:0xf bank_mask:0xf
  v_add_u32 v6, s54, v6
  v_mul_f32 v54, 986500301, v52
  v_mul_f32 v37, 986500301, v53
  v_fma_f32 v37, -v54, v54, v37
  v_max_f32 v37, 0, v37
  v_cvt_pk_bf16_f32 v37, v37, v37
  v_lshlrev_b32 v37, 16, v37
  v_cvt_pk_bf16_f32 v54, v54, v54
  v_lshlrev_b32 v54, 16, v54
  v_add_f32 v37, 925353388, v37
  v_sub_f32 v54, 0, v54
  v_cvt_pk_bf16_f32 v37, v37, v37
  v_lshlrev_b32 v37, 16, v37
  v_sqrt_f32 v52, v37
  v_dot2_f32_bf16 v36, v16, v57, v54
  v_dot2_f32_bf16 v37, v16, v58, v54
  v_dot2_f32_bf16 v38, v17, v57, v54
  v_dot2_f32_bf16 v39, v17, v58, v54
  v_dot2_f32_bf16 v40, v18, v57, v54
  v_dot2_f32_bf16 v41, v18, v58, v54
  v_dot2_f32_bf16 v42, v19, v57, v54
  v_dot2_f32_bf16 v43, v19, v58, v54
  v_dot2_f32_bf16 v44, v20, v57, v54
  v_dot2_f32_bf16 v45, v20, v58, v54
  v_dot2_f32_bf16 v46, v21, v57, v54
  v_dot2_f32_bf16 v47, v21, v58, v54
  v_dot2_f32_bf16 v48, v22, v57, v54
  v_dot2_f32_bf16 v49, v22, v58, v54
  v_dot2_f32_bf16 v50, v23, v57, v54
  v_dot2_f32_bf16 v51, v23, v58, v54
  v_cvt_pk_bf16_f32 v52, v52, v52
  v_lshlrev_b32 v52, 16, v52
  v_rcp_f32 v9, v52
  v_cvt_pk_bf16_f32 v16, v36, v37
  v_cvt_pk_bf16_f32 v17, v38, v39
  v_cvt_pk_bf16_f32 v18, v40, v41
  v_cvt_pk_bf16_f32 v19, v42, v43
  v_cvt_pk_bf16_f32 v20, v44, v45
  v_cvt_pk_bf16_f32 v21, v46, v47
  v_cvt_pk_bf16_f32 v22, v48, v49
  v_cvt_pk_bf16_f32 v23, v50, v51
  v_dot2_f32_bf16 v36, v24, v57, v54
  v_dot2_f32_bf16 v37, v24, v58, v54
  v_dot2_f32_bf16 v38, v25, v57, v54
  v_dot2_f32_bf16 v39, v25, v58, v54
  v_dot2_f32_bf16 v40, v26, v57, v54
  v_dot2_f32_bf16 v41, v26, v58, v54
  v_dot2_f32_bf16 v42, v27, v57, v54
  v_dot2_f32_bf16 v43, v27, v58, v54
  v_dot2_f32_bf16 v44, v28, v57, v54
  v_dot2_f32_bf16 v45, v28, v58, v54
  v_dot2_f32_bf16 v46, v29, v57, v54
  v_dot2_f32_bf16 v47, v29, v58, v54
  v_dot2_f32_bf16 v48, v30, v57, v54
  v_dot2_f32_bf16 v49, v30, v58, v54
  v_dot2_f32_bf16 v50, v31, v57, v54
  v_dot2_f32_bf16 v51, v31, v58, v54
  s_nop 2
  v_cvt_pk_bf16_f32 v24, v36, v37
  v_cvt_pk_bf16_f32 v25, v38, v39
  v_cvt_pk_bf16_f32 v26, v40, v41
  v_cvt_pk_bf16_f32 v27, v42, v43
  v_cvt_pk_bf16_f32 v28, v44, v45
  v_cvt_pk_bf16_f32 v29, v46, v47
  v_cvt_pk_bf16_f32 v30, v48, v49
  v_cvt_pk_bf16_f32 v31, v50, v51
  v_dot2_f32_bf16 v36, v32, v57, v54
  v_dot2_f32_bf16 v37, v32, v58, v54
  v_dot2_f32_bf16 v38, v33, v57, v54
  v_dot2_f32_bf16 v39, v33, v58, v54
  v_dot2_f32_bf16 v40, v34, v57, v54
  v_dot2_f32_bf16 v41, v34, v58, v54
  v_dot2_f32_bf16 v42, v35, v57, v54
  v_dot2_f32_bf16 v43, v35, v58, v54
  s_nop 2
  v_cvt_pk_bf16_f32 v32, v36, v37
  v_cvt_pk_bf16_f32 v33, v38, v39
  v_cvt_pk_bf16_f32 v34, v40, v41
  v_cvt_pk_bf16_f32 v35, v42, v43
  v_lshlrev_b32 v7, 2, v4
  ds_write_b32 v7, v9 offset:42240
  v_subrev_u32 v7, 40, v6
  v_min_u32 v7, v7, v6
  v_mul_u32_u24 v7, 1056, v7
  v_add_u32 v7, v7, v5
  ds_write_b128 v7, v[16:19] offset:0
  v_add_u32 v6, 8, v6
  v_subrev_u32 v7, 40, v6
  v_min_u32 v7, v7, v6
  v_mul_u32_u24 v7, 1056, v7
  v_add_u32 v7, v7, v5
  ds_write_b128 v7, v[20:23] offset:0
  v_add_u32 v6, 8, v6
  v_subrev_u32 v7, 40, v6
  v_min_u32 v7, v7, v6
  v_mul_u32_u24 v7, 1056, v7
  v_add_u32 v7, v7, v5
  ds_write_b128 v7, v[24:27] offset:0
  v_add_u32 v6, 8, v6
  v_subrev_u32 v7, 40, v6
  v_min_u32 v7, v7, v6
  v_mul_u32_u24 v7, 1056, v7
  v_add_u32 v7, v7, v5
  ds_write_b128 v7, v[28:31] offset:0
  v_add_u32 v6, 8, v6
  v_subrev_u32 v7, 40, v6
  v_min_u32 v7, v7, v6
  v_mul_u32_u24 v7, 1056, v7
  v_add_u32 v7, v7, v5
  ds_write_b128 v7, v[32:35] offset:0
  v_mul_u32_u24 v10, 528, v2
  v_lshl_add_u32 v10, v3, 4, v10
  s_cmp_ge_u32 s30, 5
  s_cbranch_scc1 A_ln5
  s_add_u32 s54, s58, 20480
  buffer_load_dwordx4 v[96:99], v12, s[44:47], s58 offen
  s_cmp_eq_u32 s54, 819200
  s_cselect_b32 s58, 0, s54
  s_add_u32 s54, s58, 20480
  buffer_load_dwordx4 v[100:103], v12, s[44:47], s58 offen
  s_cmp_eq_u32 s54, 819200
  s_cselect_b32 s58, 0, s54
  s_cmp_eq_u32 s30, 4
  s_cbranch_scc1 A_lnb
  s_add_u32 s54, s58, 20480
  buffer_load_dwordx4 v[104:107], v12, s[44:47], s58 offen
  s_cmp_eq_u32 s54, 819200
  s_cselect_b32 s58, 0, s54
  s_add_u32 s54, s58, 20480
  buffer_load_dwordx4 v[108:111], v12, s[44:47], s58 offen
  s_cmp_eq_u32 s54, 819200
  s_cselect_b32 s58, 0, s54
  s_add_u32 s54, s58, 20480
  buffer_load_dwordx4 v[112:115], v12, s[44:47], s58 offen
  s_cmp_eq_u32 s54, 819200
  s_cselect_b32 s58, 0, s54
  s_add_u32 s54, s58, 20480
  buffer_load_dwordx4 v[116:119], v12, s[44:47], s58 offen
  s_cmp_eq_u32 s54, 819200
  s_cselect_b32 s58, 0, s54
  s_add_u32 s54, s58, 20480
  buffer_load_dwordx4 v[120:123], v12, s[44:47], s58 offen
  s_cmp_eq_u32 s54, 819200
  s_cselect_b32 s58, 0, s54
  s_add_u32 s54, s58, 20480
  buffer_load_dwordx4 v[124:127], v12, s[44:47], s58 offen
  s_cmp_eq_u32 s54, 819200
  s_cselect_b32 s58, 0, s54
  s_branch A_lnb
A_ln5:
  v_mov_b32 v4, 512
  v_mov_b32 v36, 0
  v_mov_b32 v37, 0
  v_mov_b32 v38, 0
  v_mov_b32 v39, 0
  ds_write_b128 v4, v[36:39]
  ds_write_b128 v4, v[36:39] offset:528
  s_waitcnt vmcnt(0)
  v_readfirstlane_b32 s31, v61
A_lnb:
  s_waitcnt lgkmcnt(0)
  s_barrier
  v_lshlrev_b32 v4, 2, v3
  ds_read_b32 v9, v4 offset:42240
  s_cmp_ge_u32 s30, 5
  s_cbranch_scc1 A_kvp
  s_cmp_eq_u32 s30, 4
  s_cbranch_scc1 A_job4
  s_waitcnt vmcnt(15)
  ds_write_b128 v11, v[64:67] offset:0
  s_waitcnt vmcnt(14)
  ds_write_b128 v11, v[68:71] offset:1024
  s_waitcnt vmcnt(13)
  ds_write_b128 v11, v[72:75] offset:2048
  ds_read_b64_tr_b16 v[32:33], v13 offset:0
  ds_read_b64_tr_b16 v[34:35], v14 offset:0
  ds_read_b128 v[36:39], v10 offset:0
  s_waitcnt vmcnt(12)
  ds_write_b128 v11, v[76:79] offset:0
  ds_read_b64_tr_b16 v[40:41], v13 offset:1024
  ds_read_b64_tr_b16 v[42:43], v14 offset:1024
  ds_read_b128 v[44:47], v10 offset:1056
  s_waitcnt vmcnt(11)
  ds_write_b128 v11, v[80:83] offset:1024
  ds_read_b64_tr_b16 v[48:49], v13 offset:2048
  ds_read_b64_tr_b16 v[50:51], v14 offset:2048
  ds_read_b128 v[52:55], v10 offset:2112
  s_waitcnt vmcnt(10)
  ds_write_b128 v11, v[84:87] offset:2048
  ds_read_b64_tr_b16 v[56:57], v13 offset:0
  ds_read_b64_tr_b16 v[58:59], v14 offset:0
  ds_read_b128 v[60:63], v10 offset:3168
  s_waitcnt lgkmcnt(12)
  v_mfma_f32_32x32x16_bf16 v[16:31], v[32:35], v[36:39], 0
  s_add_u32 s54, s58, 20480
  buffer_load_dwordx4 v[64:67], v12, s[44:47], s58 offen
  s_cmp_eq_u32 s54, 819200
  s_cselect_b32 s58, 0, s54
  s_waitcnt vmcnt(10)
  ds_write_b128 v11, v[88:91] offset:0
  ds_read_b64_tr_b16 v[32:33], v13 offset:1024
  ds_read_b64_tr_b16 v[34:35], v14 offset:1024
  ds_read_b128 v[36:39], v10 offset:4224
  s_waitcnt lgkmcnt(12)
  v_mfma_f32_32x32x16_bf16 v[16:31], v[40:43], v[44:47], v[16:31]
  s_add_u32 s54, s58, 20480
  buffer_load_dwordx4 v[68:71], v12, s[44:47], s58 offen
  s_cmp_eq_u32 s54, 819200
  s_cselect_b32 s58, 0, s54
  s_waitcnt vmcnt(10)
  ds_write_b128 v11, v[92:95] offset:1024
  ds_read_b64_tr_b16 v[40:41], v13 offset:2048
  ds_read_b64_tr_b16 v[42:43], v14 offset:2048
  ds_read_b128 v[44:47], v10 offset:5280
  s_waitcnt lgkmcnt(12)
  v_mfma_f32_32x32x16_bf16 v[16:31], v[48:51], v[52:55], v[16:31]
  s_add_u32 s54, s58, 20480
  buffer_load_dwordx4 v[72:75], v12, s[44:47], s58 offen
  s_cmp_eq_u32 s54, 819200
  s_cselect_b32 s58, 0, s54
  s_waitcnt vmcnt(10)
  ds_write_b128 v11, v[96:99] offset:2048
  ds_read_b64_tr_b16 v[48:49], v13 offset:0
  ds_read_b64_tr_b16 v[50:51], v14 offset:0
  ds_read_b128 v[52:55], v10 offset:6336
  s_waitcnt lgkmcnt(12)
  v_mfma_f32_32x32x16_bf16 v[16:31], v[56:59], v[60:63], v[16:31]
  s_add_u32 s54, s58, 20480
  buffer_load_dwordx4 v[76:79], v12, s[44:47], s58 offen
  s_cmp_eq_u32 s54, 819200
  s_cselect_b32 s58, 0, s54
  s_waitcnt vmcnt(10)
  ds_write_b128 v11, v[100:103] offset:0
  ds_read_b64_tr_b16 v[56:57], v13 offset:1024
  ds_read_b64_tr_b16 v[58:59], v14 offset:1024
  ds_read_b128 v[60:63], v10 offset:7392
  s_waitcnt lgkmcnt(12)
  v_mfma_f32_32x32x16_bf16 v[16:31], v[32:35], v[36:39], v[16:31]
  s_add_u32 s54, s58, 20480
  buffer_load_dwordx4 v[80:83], v12, s[44:47], s58 offen
  s_cmp_eq_u32 s54, 819200
  s_cselect_b32 s58, 0, s54
  s_waitcnt vmcnt(10)
  ds_write_b128 v11, v[104:107] offset:1024
  ds_read_b64_tr_b16 v[32:33], v13 offset:2048
  ds_read_b64_tr_b16 v[34:35], v14 offset:2048
  ds_read_b128 v[36:39], v10 offset:8448
  s_waitcnt lgkmcnt(12)
  v_mfma_f32_32x32x16_bf16 v[16:31], v[40:43], v[44:47], v[16:31]
  s_add_u32 s54, s58, 20480
  buffer_load_dwordx4 v[84:87], v12, s[44:47], s58 offen
  s_cmp_eq_u32 s54, 819200
  s_cselect_b32 s58, 0, s54
  s_waitcnt vmcnt(10)
  ds_write_b128 v11, v[108:111] offset:2048
  ds_read_b64_tr_b16 v[40:41], v13 offset:0
  ds_read_b64_tr_b16 v[42:43], v14 offset:0
  ds_read_b128 v[44:47], v10 offset:9504
  s_waitcnt lgkmcnt(12)
  v_mfma_f32_32x32x16_bf16 v[16:31], v[48:51], v[52:55], v[16:31]
  s_add_u32 s54, s58, 20480
  buffer_load_dwordx4 v[88:91], v12, s[44:47], s58 offen
  s_cmp_eq_u32 s54, 819200
  s_cselect_b32 s58, 0, s54
  s_waitcnt vmcnt(10)
  ds_write_b128 v11, v[112:115] offset:0
  ds_read_b64_tr_b16 v[48:49], v13 offset:1024
  ds_read_b64_tr_b16 v[50:51], v14 offset:1024
  ds_read_b128 v[52:55], v10 offset:10560
  s_waitcnt lgkmcnt(12)
  v_mfma_f32_32x32x16_bf16 v[16:31], v[56:59], v[60:63], v[16:31]
  s_add_u32 s54, s58, 20480
  buffer_load_dwordx4 v[92:95], v12, s[44:47], s58 offen
  s_cmp_eq_u32 s54, 819200
  s_cselect_b32 s58, 0, s54
  s_waitcnt vmcnt(10)
  ds_write_b128 v11, v[116:119] offset:1024
  ds_read_b64_tr_b16 v[56:57], v13 offset:2048
  ds_read_b64_tr_b16 v[58:59], v14 offset:2048
  ds_read_b128 v[60:63], v10 offset:11616
  s_waitcnt lgkmcnt(12)
  v_mfma_f32_32x32x16_bf16 v[16:31], v[32:35], v[36:39], v[16:31]
  s_add_u32 s54, s58, 20480
  buffer_load_dwordx4 v[96:99], v12, s[44:47], s58 offen
  s_cmp_eq_u32 s54, 819200
  s_cselect_b32 s58, 0, s54
  s_waitcnt vmcnt(10)
  ds_write_b128 v11, v[120:123] offset:2048
  ds_read_b64_tr_b16 v[32:33], v13 offset:0
  ds_read_b64_tr_b16 v[34:35], v14 offset:0
  ds_read_b128 v[36:39], v10 offset:12672
  s_waitcnt lgkmcnt(12)
  v_mfma_f32_32x32x16_bf16 v[16:31], v[40:43], v[44:47], v[16:31]
  s_add_u32 s54, s58, 20480
  buffer_load_dwordx4 v[100:103], v12, s[44:47], s58 offen
  s_cmp_eq_u32 s54, 819200
  s_cselect_b32 s58, 0, s54
  s_waitcnt vmcnt(10)
  ds_write_b128 v11, v[124:127] offset:0
  ds_read_b64_tr_b16 v[40:41], v13 offset:1024
  ds_read_b64_tr_b16 v[42:43], v14 offset:1024
  ds_read_b128 v[44:47], v10 offset:13728
  s_waitcnt lgkmcnt(12)
  v_mfma_f32_32x32x16_bf16 v[16:31], v[48:51], v[52:55], v[16:31]
  s_add_u32 s54, s58, 20480
  buffer_load_dwordx4 v[104:107], v12, s[44:47], s58 offen
  s_cmp_eq_u32 s54, 819200
  s_cselect_b32 s58, 0, s54
  s_waitcnt vmcnt(10)
  ds_write_b128 v11, v[64:67] offset:1024
  ds_read_b64_tr_b16 v[48:49], v13 offset:2048
  ds_read_b64_tr_b16 v[50:51], v14 offset:2048
  ds_read_b128 v[52:55], v10 offset:14784
  s_waitcnt lgkmcnt(12)
  v_mfma_f32_32x32x16_bf16 v[16:31], v[56:59], v[60:63], v[16:31]
  s_add_u32 s54, s58, 20480
  buffer_load_dwordx4 v[108:111], v12, s[44:47], s58 offen
  s_cmp_eq_u32 s54, 819200
  s_cselect_b32 s58, 0, s54
  s_waitcnt vmcnt(10)
  ds_write_b128 v11, v[68:71] offset:2048
  ds_read_b64_tr_b16 v[56:57], v13 offset:0
  ds_read_b64_tr_b16 v[58:59], v14 offset:0
  ds_read_b128 v[60:63], v10 offset:15840
  s_waitcnt lgkmcnt(12)
  v_mfma_f32_32x32x16_bf16 v[16:31], v[32:35], v[36:39], v[16:31]
  s_add_u32 s54, s58, 20480
  buffer_load_dwordx4 v[112:115], v12, s[44:47], s58 offen
  s_cmp_eq_u32 s54, 819200
  s_cselect_b32 s58, 0, s54
  s_waitcnt vmcnt(10)
  ds_write_b128 v11, v[72:75] offset:0
  ds_read_b64_tr_b16 v[32:33], v13 offset:1024
  ds_read_b64_tr_b16 v[34:35], v14 offset:1024
  ds_read_b128 v[36:39], v10 offset:16896
  s_waitcnt lgkmcnt(12)
  v_mfma_f32_32x32x16_bf16 v[16:31], v[40:43], v[44:47], v[16:31]
  s_add_u32 s54, s58, 20480
  buffer_load_dwordx4 v[116:119], v12, s[44:47], s58 offen
  s_cmp_eq_u32 s54, 819200
  s_cselect_b32 s58, 0, s54
  s_waitcnt vmcnt(10)
  ds_write_b128 v11, v[76:79] offset:1024
  ds_read_b64_tr_b16 v[40:41], v13 offset:2048
  ds_read_b64_tr_b16 v[42:43], v14 offset:2048
  ds_read_b128 v[44:47], v10 offset:17952
  s_waitcnt lgkmcnt(12)
  v_mfma_f32_32x32x16_bf16 v[16:31], v[48:51], v[52:55], v[16:31]
  s_add_u32 s54, s58, 20480
  buffer_load_dwordx4 v[120:123], v12, s[44:47], s58 offen
  s_cmp_eq_u32 s54, 819200
  s_cselect_b32 s58, 0, s54
  s_waitcnt vmcnt(10)
  ds_write_b128 v11, v[80:83] offset:2048
  ds_read_b64_tr_b16 v[48:49], v13 offset:0
  ds_read_b64_tr_b16 v[50:51], v14 offset:0
  ds_read_b128 v[52:55], v10 offset:19008
  s_waitcnt lgkmcnt(12)
  v_mfma_f32_32x32x16_bf16 v[16:31], v[56:59], v[60:63], v[16:31]
  s_add_u32 s54, s58, 20480
  buffer_load_dwordx4 v[124:127], v12, s[44:47], s58 offen
  s_cmp_eq_u32 s54, 819200
  s_cselect_b32 s58, 0, s54
  s_waitcnt vmcnt(10)
  ds_write_b128 v11, v[84:87] offset:0
  ds_read_b64_tr_b16 v[56:57], v13 offset:1024
  ds_read_b64_tr_b16 v[58:59], v14 offset:1024
  ds_read_b128 v[60:63], v10 offset:20064
  s_waitcnt lgkmcnt(12)
  v_mfma_f32_32x32x16_bf16 v[16:31], v[32:35], v[36:39], v[16:31]
  s_add_u32 s54, s58, 20480
  buffer_load_dwordx4 v[64:67], v12, s[44:47], s58 offen
  s_cmp_eq_u32 s54, 819200
  s_cselect_b32 s58, 0, s54
  s_waitcnt vmcnt(10)
  ds_write_b128 v11, v[88:91] offset:1024
  ds_read_b64_tr_b16 v[32:33], v13 offset:2048
  ds_read_b64_tr_b16 v[34:35], v14 offset:2048
  ds_read_b128 v[36:39], v10 offset:21120
  s_waitcnt lgkmcnt(12)
  v_mfma_f32_32x32x16_bf16 v[16:31], v[40:43], v[44:47], v[16:31]
  s_add_u32 s54, s58, 20480
  buffer_load_dwordx4 v[68:71], v12, s[44:47], s58 offen
  s_cmp_eq_u32 s54, 819200
  s_cselect_b32 s58, 0, s54
  s_waitcnt vmcnt(10)
  ds_write_b128 v11, v[92:95] offset:2048
  ds_read_b64_tr_b16 v[40:41], v13 offset:0
  ds_read_b64_tr_b16 v[42:43], v14 offset:0
  ds_read_b128 v[44:47], v10 offset:22176
  s_waitcnt lgkmcnt(12)
  v_mfma_f32_32x32x16_bf16 v[16:31], v[48:51], v[52:55], v[16:31]
  s_add_u32 s54, s58, 20480
  buffer_load_dwordx4 v[72:75], v12, s[44:47], s58 offen
  s_cmp_eq_u32 s54, 819200
  s_cselect_b32 s58, 0, s54
  s_waitcnt vmcnt(10)
  ds_write_b128 v11, v[96:99] offset:0
  ds_read_b64_tr_b16 v[48:49], v13 offset:1024
  ds_read_b64_tr_b16 v[50:51], v14 offset:1024
  ds_read_b128 v[52:55], v10 offset:23232
  s_waitcnt lgkmcnt(12)
  v_mfma_f32_32x32x16_bf16 v[16:31], v[56:59], v[60:63], v[16:31]
  s_add_u32 s54, s58, 20480
  buffer_load_dwordx4 v[76:79], v12, s[44:47], s58 offen
  s_cmp_eq_u32 s54, 819200
  s_cselect_b32 s58, 0, s54
  s_waitcnt vmcnt(10)
  ds_write_b128 v11, v[100:103] offset:1024
  ds_read_b64_tr_b16 v[56:57], v13 offset:2048
  ds_read_b64_tr_b16 v[58:59], v14 offset:2048
  ds_read_b128 v[60:63], v10 offset:24288
  s_waitcnt lgkmcnt(12)
  v_mfma_f32_32x32x16_bf16 v[16:31], v[32:35], v[36:39], v[16:31]
  s_add_u32 s54, s58, 20480
  buffer_load_dwordx4 v[80:83], v12, s[44:47], s58 offen
  s_cmp_eq_u32 s54, 819200
  s_cselect_b32 s58, 0, s54
  s_waitcnt vmcnt(10)
  ds_write_b128 v11, v[104:107] offset:2048
  ds_read_b64_tr_b16 v[32:33], v13 offset:0
  ds_read_b64_tr_b16 v[34:35], v14 offset:0
  ds_read_b128 v[36:39], v10 offset:25344
  s_waitcnt lgkmcnt(12)
  v_mfma_f32_32x32x16_bf16 v[16:31], v[40:43], v[44:47], v[16:31]
  s_add_u32 s54, s58, 20480
  buffer_load_dwordx4 v[84:87], v12, s[44:47], s58 offen
  s_cmp_eq_u32 s54, 819200
  s_cselect_b32 s58, 0, s54
  s_waitcnt vmcnt(10)
  ds_write_b128 v11, v[108:111] offset:0
  ds_read_b64_tr_b16 v[40:41], v13 offset:1024
  ds_read_b64_tr_b16 v[42:43], v14 offset:1024
  ds_read_b128 v[44:47], v10 offset:26400
  s_waitcnt lgkmcnt(12)
  v_mfma_f32_32x32x16_bf16 v[16:31], v[48:51], v[52:55], v[16:31]
  s_add_u32 s54, s58, 20480
  buffer_load_dwordx4 v[88:91], v12, s[44:47], s58 offen
  s_cmp_eq_u32 s54, 819200
  s_cselect_b32 s58, 0, s54
  s_waitcnt vmcnt(10)
  ds_write_b128 v11, v[112:115] offset:1024
  ds_read_b64_tr_b16 v[48:49], v13 offset:2048
  ds_read_b64_tr_b16 v[50:51], v14 offset:2048
  ds_read_b128 v[52:55], v10 offset:27456
  s_waitcnt lgkmcnt(12)
  v_mfma_f32_32x32x16_bf16 v[16:31], v[56:59], v[60:63], v[16:31]
  s_add_u32 s54, s58, 20480
  buffer_load_dwordx4 v[92:95], v12, s[44:47], s58 offen
  s_cmp_eq_u32 s54, 819200
  s_cselect_b32 s58, 0, s54
  s_waitcnt vmcnt(10)
  ds_write_b128 v11, v[116:119] offset:2048
  ds_read_b64_tr_b16 v[56:57], v13 offset:0
  ds_read_b64_tr_b16 v[58:59], v14 offset:0
  ds_read_b128 v[60:63], v10 offset:28512
  s_waitcnt lgkmcnt(12)
  v_mfma_f32_32x32x16_bf16 v[16:31], v[32:35], v[36:39], v[16:31]
  s_waitcnt vmcnt(9)
  ds_write_b128 v11, v[120:123] offset:0
  ds_read_b64_tr_b16 v[32:33], v13 offset:1024
  ds_read_b64_tr_b16 v[34:35], v14 offset:1024
  ds_read_b128 v[36:39], v10 offset:29568
  s_waitcnt lgkmcnt(12)
  v_mfma_f32_32x32x16_bf16 v[16:31], v[40:43], v[44:47], v[16:31]
  s_waitcnt vmcnt(8)
  ds_write_b128 v11, v[124:127] offset:1024
  ds_read_b64_tr_b16 v[40:41], v13 offset:2048
  ds_read_b64_tr_b16 v[42:43], v14 offset:2048
  ds_read_b128 v[44:47], v10 offset:30624
  s_waitcnt lgkmcnt(12)
  v_mfma_f32_32x32x16_bf16 v[16:31], v[48:51], v[52:55], v[16:31]
  s_waitcnt vmcnt(7)
  ds_write_b128 v11, v[64:67] offset:2048
  ds_read_b64_tr_b16 v[48:49], v13 offset:0
  ds_read_b64_tr_b16 v[50:51], v14 offset:0
  ds_read_b128 v[52:55], v10 offset:31680
  s_waitcnt lgkmcnt(12)
  v_mfma_f32_32x32x16_bf16 v[16:31], v[56:59], v[60:63], v[16:31]
  s_waitcnt vmcnt(6)
  ds_write_b128 v11, v[68:71] offset:0
  ds_read_b64_tr_b16 v[56:57], v13 offset:1024
  ds_read_b64_tr_b16 v[58:59], v14 offset:1024
  ds_read_b128 v[60:63], v10 offset:32736
  s_waitcnt lgkmcnt(12)
  v_mfma_f32_32x32x16_bf16 v[16:31], v[32:35], v[36:39], v[16:31]
  s_waitcnt vmcnt(5)
  ds_write_b128 v11, v[72:75] offset:1024
  ds_read_b64_tr_b16 v[32:33], v13 offset:2048
  ds_read_b64_tr_b16 v[34:35], v14 offset:2048
  ds_read_b128 v[36:39], v10 offset:33792
  s_waitcnt lgkmcnt(12)
  v_mfma_f32_32x32x16_bf16 v[16:31], v[40:43], v[44:47], v[16:31]
  s_waitcnt vmcnt(4)
  ds_write_b128 v11, v[76:79] offset:2048
  ds_read_b64_tr_b16 v[40:41], v13 offset:0
  ds_read_b64_tr_b16 v[42:43], v14 offset:0
  ds_read_b128 v[44:47], v10 offset:34848
  s_waitcnt lgkmcnt(12)
  v_mfma_f32_32x32x16_bf16 v[16:31], v[48:51], v[52:55], v[16:31]
  s_waitcnt vmcnt(3)
  ds_write_b128 v11, v[80:83] offset:0
  ds_read_b64_tr_b16 v[48:49], v13 offset:1024
  ds_read_b64_tr_b16 v[50:51], v14 offset:1024
  ds_read_b128 v[52:55], v10 offset:35904
  s_waitcnt lgkmcnt(12)
  v_mfma_f32_32x32x16_bf16 v[16:31], v[56:59], v[60:63], v[16:31]
  s_waitcnt vmcnt(2)
  ds_write_b128 v11, v[84:87] offset:1024
  ds_read_b64_tr_b16 v[56:57], v13 offset:2048
  ds_read_b64_tr_b16 v[58:59], v14 offset:2048
  ds_read_b128 v[60:63], v10 offset:36960
  s_waitcnt lgkmcnt(12)
  v_mfma_f32_32x32x16_bf16 v[16:31], v[32:35], v[36:39], v[16:31]
  s_waitcnt vmcnt(1)
  ds_write_b128 v11, v[88:91] offset:2048
  ds_read_b64_tr_b16 v[32:33], v13 offset:0
  ds_read_b64_tr_b16 v[34:35], v14 offset:0
  ds_read_b128 v[36:39], v10 offset:38016
  s_waitcnt lgkmcnt(12)
  v_mfma_f32_32x32x16_bf16 v[16:31], v[40:43], v[44:47], v[16:31]
  s_waitcnt vmcnt(0)
  ds_write_b128 v11, v[92:95] offset:0
  ds_read_b64_tr_b16 v[40:41], v13 offset:1024
  ds_read_b64_tr_b16 v[42:43], v14 offset:1024
  ds_read_b128 v[44:47], v10 offset:39072
  s_waitcnt lgkmcnt(12)
  v_mfma_f32_32x32x16_bf16 v[16:31], v[48:51], v[52:55], v[16:31]
  ds_read_b64_tr_b16 v[48:49], v13 offset:2048
  ds_read_b64_tr_b16 v[50:51], v14 offset:2048
  ds_read_b128 v[52:55], v10 offset:40128
  s_waitcnt lgkmcnt(11)
  v_mfma_f32_32x32x16_bf16 v[16:31], v[56:59], v[60:63], v[16:31]
  ds_read_b64_tr_b16 v[56:57], v13 offset:0
  ds_read_b64_tr_b16 v[58:59], v14 offset:0
  ds_read_b128 v[60:63], v10 offset:41184
  s_waitcnt lgkmcnt(10)
  v_mfma_f32_32x32x16_bf16 v[16:31], v[32:35], v[36:39], v[16:31]
  s_waitcnt lgkmcnt(6)
  v_mfma_f32_32x32x16_bf16 v[16:31], v[40:43], v[44:47], v[16:31]
  s_waitcnt lgkmcnt(3)
  v_mfma_f32_32x32x16_bf16 v[16:31], v[48:51], v[52:55], v[16:31]
  s_waitcnt lgkmcnt(0)
  v_mfma_f32_32x32x16_bf16 v[16:31], v[56:59], v[60:63], v[16:31]
  s_nop 11
  v_mul_f32 v4, 1051011932, v9
  v_mul_f32 v16, v16, v4
  v_mul_f32 v17, v17, v4
  v_mul_f32 v18, v18, v4
  v_mul_f32 v19, v19, v4
  v_mul_f32 v20, v20, v4
  v_mul_f32 v21, v21, v4
  v_mul_f32 v22, v22, v4
  v_mul_f32 v23, v23, v4
  v_mul_f32 v24, v24, v4
  v_mul_f32 v25, v25, v4
  v_mul_f32 v26, v26, v4
  v_mul_f32 v27, v27, v4
  v_mul_f32 v28, v28, v4
  v_mul_f32 v29, v29, v4
  v_mul_f32 v30, v30, v4
  v_mul_f32 v31, v31, v4
  v_cvt_pk_bf16_f32 v36, v16, v17
  v_cvt_pk_bf16_f32 v37, v18, v19
  v_cvt_pk_bf16_f32 v38, v20, v21
  v_cvt_pk_bf16_f32 v39, v22, v23
  v_cvt_pk_bf16_f32 v40, v24, v25
  v_cvt_pk_bf16_f32 v41, v26, v27
  v_cvt_pk_bf16_f32 v42, v28, v29
  v_cvt_pk_bf16_f32 v43, v30, v31
  s_branch A_bar1
A_job4:
  v_bfe_u32 v4, v1, 2, 2
  v_mul_u32_u24 v5, 8, v2
  v_add_u32 v4, v4, v5
  v_bfe_u32 v5, v1, 4, 1
  v_and_b32 v6, 3, v1
  v_lshlrev_b32 v6, 3, v6
  v_lshl_add_u32 v5, v5, 5, v6
  v_mul_u32_u24 v13, 64, v4
  v_add3_u32 v13, v13, v5, s59
  v_add_u32 v14, 256, v13
  v_add_u32 v11, s59, v15
  s_sub_u32 s54, s30, 4
  s_mul_i32 s54, s54, 10560
  v_add_u32 v12, s54, v10
  s_waitcnt vmcnt(9)
  ds_write_b128 v11, v[64:67] offset:0
  s_waitcnt vmcnt(8)
  ds_write_b128 v11, v[68:71] offset:1024
  s_waitcnt vmcnt(7)
  ds_write_b128 v11, v[72:75] offset:2048
  ds_read_b64_tr_b16 v[32:33], v13 offset:0
  ds_read_b64_tr_b16 v[34:35], v14 offset:0
  ds_read_b128 v[36:39], v12 offset:0
  s_waitcnt vmcnt(6)
  ds_write_b128 v11, v[76:79] offset:0
  ds_read_b64_tr_b16 v[40:41], v13 offset:1024
  ds_read_b64_tr_b16 v[42:43], v14 offset:1024
  ds_read_b128 v[44:47], v12 offset:1056
  s_waitcnt vmcnt(5)
  ds_write_b128 v11, v[80:83] offset:1024
  ds_read_b64_tr_b16 v[48:49], v13 offset:2048
  ds_read_b64_tr_b16 v[50:51], v14 offset:2048
  ds_read_b128 v[52:55], v12 offset:2112
  s_waitcnt vmcnt(4)
  ds_write_b128 v11, v[84:87] offset:2048
  ds_read_b64_tr_b16 v[56:57], v13 offset:0
  ds_read_b64_tr_b16 v[58:59], v14 offset:0
  ds_read_b128 v[60:63], v12 offset:3168
  s_waitcnt lgkmcnt(12)
  v_mfma_f32_32x32x16_bf16 v[16:31], v[32:35], v[36:39], 0
  s_waitcnt vmcnt(3)
  ds_write_b128 v11, v[88:91] offset:0
  ds_read_b64_tr_b16 v[32:33], v13 offset:1024
  ds_read_b64_tr_b16 v[34:35], v14 offset:1024
  ds_read_b128 v[36:39], v12 offset:4224
  s_waitcnt lgkmcnt(12)
  v_mfma_f32_32x32x16_bf16 v[16:31], v[40:43], v[44:47], v[16:31]
  s_waitcnt vmcnt(2)
  ds_write_b128 v11, v[92:95] offset:1024
  ds_read_b64_tr_b16 v[40:41], v13 offset:2048
  ds_read_b64_tr_b16 v[42:43], v14 offset:2048
  ds_read_b128 v[44:47], v12 offset:5280
  s_waitcnt lgkmcnt(12)
  v_mfma_f32_32x32x16_bf16 v[16:31], v[48:51], v[52:55], v[16:31]
  s_waitcnt vmcnt(1)
  ds_write_b128 v11, v[96:99] offset:2048
  ds_read_b64_tr_b16 v[48:49], v13 offset:0
  ds_read_b64_tr_b16 v[50:51], v14 offset:0
  ds_read_b128 v[52:55], v12 offset:6336
  s_waitcnt lgkmcnt(12)
  v_mfma_f32_32x32x16_bf16 v[16:31], v[56:59], v[60:63], v[16:31]
  s_waitcnt vmcnt(0)
  ds_write_b128 v11, v[100:103] offset:0
  ds_read_b64_tr_b16 v[56:57], v13 offset:1024
  ds_read_b64_tr_b16 v[58:59], v14 offset:1024
  ds_read_b128 v[60:63], v12 offset:7392
  s_waitcnt lgkmcnt(12)
  v_mfma_f32_32x32x16_bf16 v[16:31], v[32:35], v[36:39], v[16:31]
  ds_read_b64_tr_b16 v[32:33], v13 offset:2048
  ds_read_b64_tr_b16 v[34:35], v14 offset:2048
  ds_read_b128 v[36:39], v12 offset:8448
  s_waitcnt lgkmcnt(11)
  v_mfma_f32_32x32x16_bf16 v[16:31], v[40:43], v[44:47], v[16:31]
  ds_read_b64_tr_b16 v[40:41], v13 offset:0
  ds_read_b64_tr_b16 v[42:43], v14 offset:0
  ds_read_b128 v[44:47], v12 offset:9504
  s_waitcnt lgkmcnt(10)
  v_mfma_f32_32x32x16_bf16 v[16:31], v[48:51], v[52:55], v[16:31]
  s_waitcnt lgkmcnt(6)
  v_mfma_f32_32x32x16_bf16 v[16:31], v[56:59], v[60:63], v[16:31]
  s_waitcnt lgkmcnt(3)
  v_mfma_f32_32x32x16_bf16 v[16:31], v[32:35], v[36:39], v[16:31]
  s_waitcnt lgkmcnt(0)
  v_mfma_f32_32x32x16_bf16 v[16:31], v[40:43], v[44:47], v[16:31]
  s_waitcnt lgkmcnt(0)
  s_nop 11
  v_mov_b32 v4, 1040
  s_mov_b32 s56, 200063
A_j4spin:
  ds_read_b96 v[6:8], v4
  s_waitcnt lgkmcnt(0)
  v_and_b32 v6, v6, v7
  v_and_b32 v6, v6, v8
  s_nop 0
  v_readfirstlane_b32 s54, v6
  s_sub_u32 s56, s56, 1
  s_cmp_eq_u32 s56, 0
  s_cbranch_scc1 A_j4spin_done
  s_cmp_eq_u32 s54, 1
  s_cbranch_scc1 A_j4spin_done
  s_sleep 1
  s_branch A_j4spin
A_j4spin_done:
  v_add_u32 v4, 71168, v15
  v_add_u32 v5, 60928, v15
  v_add_u32 v6, 75264, v15
  ds_read_b128 v[64:67], v4 offset:0
  ds_read_b128 v[68:71], v4 offset:1024
  ds_read_b128 v[72:75], v4 offset:2048
  ds_read_b128 v[76:79], v4 offset:3072
  ds_read_b128 v[80:83], v5 offset:0
  ds_read_b128 v[84:87], v5 offset:1024
  ds_read_b128 v[88:91], v5 offset:2048
  ds_read_b128 v[92:95], v6 offset:0
  ds_read_b128 v[96:99], v5 offset:3072
  ds_read_b128 v[100:103], v5 offset:4096
  ds_read_b128 v[104:107], v5 offset:5120
  ds_read_b128 v[108:111], v6 offset:1024
  s_waitcnt lgkmcnt(0)
  v_add_f32 v64, v64, v80
  v_add_f32 v65, v65, v81
  v_add_f32 v66, v66, v82
  v_add_f32 v67, v67, v83
  v_add_f32 v68, v68, v84
  v_add_f32 v69, v69, v85
  v_add_f32 v70, v70, v86
  v_add_f32 v71, v71, v87
  v_add_f32 v72, v72, v88
  v_add_f32 v73, v73, v89
  v_add_f32 v74, v74, v90
  v_add_f32 v75, v75, v91
  v_add_f32 v76, v76, v92
  v_add_f32 v77, v77, v93
  v_add_f32 v78, v78, v94
  v_add_f32 v79, v79, v95
  v_add_f32 v16, v16, v96
  v_add_f32 v17, v17, v97
  v_add_f32 v18, v18, v98
  v_add_f32 v19, v19, v99
  v_add_f32 v20, v20, v100
  v_add_f32 v21, v21, v101
  v_add_f32 v22, v22, v102
  v_add_f32 v23, v23, v103
  v_add_f32 v24, v24, v104
  v_add_f32 v25, v25, v105
  v_add_f32 v26, v26, v106
  v_add_f32 v27, v27, v107
  v_add_f32 v28, v28, v108
  v_add_f32 v29, v29, v109
  v_add_f32 v30, v30, v110
  v_add_f32 v31, v31, v111
  v_add_f32 v16, v16, v64
  v_add_f32 v17, v17, v65
  v_add_f32 v18, v18, v66
  v_add_f32 v19, v19, v67
  v_add_f32 v20, v20, v68
  v_add_f32 v21, v21, v69
  v_add_f32 v22, v22, v70
  v_add_f32 v23, v23, v71
  v_add_f32 v24, v24, v72
  v_add_f32 v25, v25, v73
  v_add_f32 v26, v26, v74
  v_add_f32 v27, v27, v75
  v_add_f32 v28, v28, v76
  v_add_f32 v29, v29, v77
  v_add_f32 v30, v30, v78
  v_add_f32 v31, v31, v79
  v_mul_f32 v4, 1051011932, v9
  v_mul_f32 v16, v16, v4
  v_mul_f32 v17, v17, v4
  v_mul_f32 v18, v18, v4
  v_mul_f32 v19, v19, v4
  v_mul_f32 v20, v20, v4
  v_mul_f32 v21, v21, v4
  v_mul_f32 v22, v22, v4
  v_mul_f32 v23, v23, v4
  v_mul_f32 v24, v24, v4
  v_mul_f32 v25, v25, v4
  v_mul_f32 v26, v26, v4
  v_mul_f32 v27, v27, v4
  v_mul_f32 v28, v28, v4
  v_mul_f32 v29, v29, v4
  v_mul_f32 v30, v30, v4
  v_mul_f32 v31, v31, v4
  v_cvt_pk_bf16_f32 v36, v16, v17
  v_cvt_pk_bf16_f32 v37, v18, v19
  v_cvt_pk_bf16_f32 v38, v20, v21
  v_cvt_pk_bf16_f32 v39, v22, v23
  v_cvt_pk_bf16_f32 v40, v24, v25
  v_cvt_pk_bf16_f32 v41, v26, v27
  v_cvt_pk_bf16_f32 v42, v28, v29
  v_cvt_pk_bf16_f32 v43, v30, v31
  s_branch A_bar1
A_kvp:
  s_setprio 3
  s_cmp_ge_u32 s53, 2
  s_cbranch_scc1 A_kvp_skip
  s_sub_u32 s54, s30, 5
  s_mul_i32 s59, s54, 3072
  s_add_u32 s59, s59, 57856
  v_bfe_u32 v4, v1, 2, 2
  v_mul_u32_u24 v5, 8, v2
  v_add_u32 v4, v4, v5
  v_bfe_u32 v5, v1, 4, 1
  v_and_b32 v6, 3, v1
  v_lshlrev_b32 v6, 3, v6
  v_lshl_add_u32 v5, v5, 5, v6
  v_mul_u32_u24 v13, 40, v4
  v_add3_u32 v13, v13, v5, s59
  v_add_u32 v14, 160, v13
  v_add_u32 v11, s59, v15
  s_mul_i32 s54, s57, 1056
  v_add_u32 v12, s54, v10
  v_add_u32 v8, 13728, v12
  s_cmp_eq_u32 s30, 5
  s_cbranch_scc1 A_kv13
  v_mov_b32 v116, 0
  v_mov_b32 v117, 0
  v_mov_b32 v118, 0
  v_mov_b32 v119, 0
  v_mov_b32 v8, v10
A_kv13:
  ds_write_b128 v11, v[64:67] offset:0
  ds_write_b128 v11, v[68:71] offset:1024
  ds_write_b128 v11, v[72:75] offset:2048
  ds_read_b64_tr_b16 v[32:33], v13 offset:0
  ds_read_b64_tr_b16 v[34:35], v14 offset:0
  ds_read_b128 v[36:39], v12 offset:0
  ds_write_b128 v11, v[76:79] offset:0
  ds_read_b64_tr_b16 v[40:41], v13 offset:1024
  ds_read_b64_tr_b16 v[42:43], v14 offset:1024
  ds_read_b128 v[44:47], v12 offset:1056
  ds_write_b128 v11, v[80:83] offset:1024
  ds_read_b64_tr_b16 v[48:49], v13 offset:2048
  ds_read_b64_tr_b16 v[50:51], v14 offset:2048
  ds_read_b128 v[52:55], v12 offset:2112
  ds_write_b128 v11, v[84:87] offset:2048
  ds_read_b64_tr_b16 v[56:57], v13 offset:0
  ds_read_b64_tr_b16 v[58:59], v14 offset:0
  ds_read_b128 v[60:63], v12 offset:3168
  s_waitcnt lgkmcnt(12)
  v_mfma_f32_32x32x16_bf16 v[16:31], v[32:35], v[36:39], 0
  ds_write_b128 v11, v[88:91] offset:0
  ds_read_b64_tr_b16 v[32:33], v13 offset:1024
  ds_read_b64_tr_b16 v[34:35], v14 offset:1024
  ds_read_b128 v[36:39], v12 offset:4224
  s_waitcnt lgkmcnt(12)
  v_mfma_f32_32x32x16_bf16 v[16:31], v[40:43], v[44:47], v[16:31]
  ds_write_b128 v11, v[92:95] offset:1024
  ds_read_b64_tr_b16 v[40:41], v13 offset:2048
  ds_read_b64_tr_b16 v[42:43], v14 offset:2048
  ds_read_b128 v[44:47], v12 offset:5280
  s_waitcnt lgkmcnt(12)
  v_mfma_f32_32x32x16_bf16 v[16:31], v[48:51], v[52:55], v[16:31]
  ds_write_b128 v11, v[96:99] offset:2048
  ds_read_b64_tr_b16 v[48:49], v13 offset:0
  ds_read_b64_tr_b16 v[50:51], v14 offset:0
  ds_read_b128 v[52:55], v12 offset:6336
  s_waitcnt lgkmcnt(12)
  v_mfma_f32_32x32x16_bf16 v[16:31], v[56:59], v[60:63], v[16:31]
  ds_write_b128 v11, v[100:103] offset:0
  ds_read_b64_tr_b16 v[56:57], v13 offset:1024
  ds_read_b64_tr_b16 v[58:59], v14 offset:1024
  ds_read_b128 v[60:63], v12 offset:7392
  s_waitcnt lgkmcnt(12)
  v_mfma_f32_32x32x16_bf16 v[16:31], v[32:35], v[36:39], v[16:31]
  ds_write_b128 v11, v[104:107] offset:1024
  ds_read_b64_tr_b16 v[32:33], v13 offset:2048
  ds_read_b64_tr_b16 v[34:35], v14 offset:2048
  ds_read_b128 v[36:39], v12 offset:8448
  s_waitcnt lgkmcnt(12)
  v_mfma_f32_32x32x16_bf16 v[16:31], v[40:43], v[44:47], v[16:31]
  ds_write_b128 v11, v[108:111] offset:2048
  ds_read_b64_tr_b16 v[40:41], v13 offset:0
  ds_read_b64_tr_b16 v[42:43], v14 offset:0
  ds_read_b128 v[44:47], v12 offset:9504
  s_waitcnt lgkmcnt(12)
  v_mfma_f32_32x32x16_bf16 v[16:31], v[48:51], v[52:55], v[16:31]
  ds_write_b128 v11, v[112:115] offset:0
  ds_read_b64_tr_b16 v[48:49], v13 offset:1024
  ds_read_b64_tr_b16 v[50:51], v14 offset:1024
  ds_read_b128 v[52:55], v12 offset:10560
  s_waitcnt lgkmcnt(12)
  v_mfma_f32_32x32x16_bf16 v[16:31], v[56:59], v[60:63], v[16:31]
  ds_write_b128 v11, v[116:119] offset:1024
  ds_read_b64_tr_b16 v[56:57], v13 offset:2048
  ds_read_b64_tr_b16 v[58:59], v14 offset:2048
  ds_read_b128 v[60:63], v12 offset:11616
  s_waitcnt lgkmcnt(12)
  v_mfma_f32_32x32x16_bf16 v[16:31], v[32:35], v[36:39], v[16:31]
  ds_read_b64_tr_b16 v[32:33], v13 offset:0
  ds_read_b64_tr_b16 v[34:35], v14 offset:0
  ds_read_b128 v[36:39], v12 offset:12672
  s_waitcnt lgkmcnt(11)
  v_mfma_f32_32x32x16_bf16 v[16:31], v[40:43], v[44:47], v[16:31]
  ds_read_b64_tr_b16 v[40:41], v13 offset:1024
  ds_read_b64_tr_b16 v[42:43], v14 offset:1024
  ds_read_b128 v[44:47], v8
  s_waitcnt lgkmcnt(10)
  v_mfma_f32_32x32x16_bf16 v[16:31], v[48:51], v[52:55], v[16:31]
  s_waitcnt lgkmcnt(6)
  v_mfma_f32_32x32x16_bf16 v[16:31], v[56:59], v[60:63], v[16:31]
  s_waitcnt lgkmcnt(3)
  v_mfma_f32_32x32x16_bf16 v[16:31], v[32:35], v[36:39], v[16:31]
  s_waitcnt lgkmcnt(0)
  v_mfma_f32_32x32x16_bf16 v[16:31], v[40:43], v[44:47], v[16:31]
  s_waitcnt lgkmcnt(0)
  s_mov_b32 s44, s6
  s_mov_b32 s45, s7
  s_mov_b32 s46, 819200
  s_mov_b32 s47, 0x00020000
  v_lshrrev_b32 v4, 2, v1
  v_mul_u32_u24 v4, 1280, v4
  v_and_b32 v5, 3, v1
  v_lshl_add_u32 v4, v5, 4, v4
  s_mul_i32 s54, s53, 320
  s_add_u32 s54, s54, 256
  v_add_u32 v4, s54, v4
  s_sub_u32 s54, s30, 4
  s_mul_i32 s54, s54, 10
  s_mul_i32 s55, s60, 5
  s_add_u32 s54, s54, s55
  s_cmp_ge_u32 s54, 40
  s_cselect_b32 s55, 40, 0
  s_sub_u32 s54, s54, s55
  s_mul_i32 s58, s54, 20480
  s_add_u32 s54, s58, 20480
  buffer_load_dwordx4 v[84:87], v4, s[44:47], s58 offen
  s_cmp_eq_u32 s54, 819200
  s_cselect_b32 s58, 0, s54
  s_add_u32 s54, s58, 20480
  buffer_load_dwordx4 v[88:91], v4, s[44:47], s58 offen
  s_cmp_eq_u32 s54, 819200
  s_cselect_b32 s58, 0, s54
  s_add_u32 s54, s58, 20480
  buffer_load_dwordx4 v[92:95], v4, s[44:47], s58 offen
  s_cmp_eq_u32 s54, 819200
  s_cselect_b32 s58, 0, s54
  s_add_u32 s54, s58, 20480
  buffer_load_dwordx4 v[96:99], v4, s[44:47], s58 offen
  s_cmp_eq_u32 s54, 819200
  s_cselect_b32 s58, 0, s54
  s_add_u32 s54, s58, 20480
  buffer_load_dwordx4 v[100:103], v4, s[44:47], s58 offen
  s_cmp_eq_u32 s54, 819200
  s_cselect_b32 s58, 0, s54
  s_add_u32 s54, s58, 20480
  buffer_load_dwordx4 v[104:107], v4, s[44:47], s58 offen
  s_cmp_eq_u32 s54, 819200
  s_cselect_b32 s58, 0, s54
  s_add_u32 s54, s58, 20480
  buffer_load_dwordx4 v[108:111], v4, s[44:47], s58 offen
  s_cmp_eq_u32 s54, 819200
  s_cselect_b32 s58, 0, s54
  s_add_u32 s54, s58, 20480
  buffer_load_dwordx4 v[112:115], v4, s[44:47], s58 offen
  s_cmp_eq_u32 s54, 819200
  s_cselect_b32 s58, 0, s54
  s_add_u32 s54, s58, 20480
  buffer_load_dwordx4 v[116:119], v4, s[44:47], s58 offen
  s_cmp_eq_u32 s54, 819200
  s_cselect_b32 s58, 0, s54
  s_add_u32 s54, s58, 20480
  buffer_load_dwordx4 v[120:123], v4, s[44:47], s58 offen
  s_cmp_eq_u32 s54, 819200
  s_cselect_b32 s58, 0, s54
  s_cmp_eq_u32 s30, 5
  s_cbranch_scc1 A_kv5
  s_sub_u32 s54, s30, 6
  s_lshl_b32 s54, s54, 12
  s_add_u32 s54, s54, 67072
  v_add_u32 v4, s54, v15
  ds_write_b128 v4, v[16:19] offset:0
  ds_write_b128 v4, v[20:23] offset:1024
  ds_write_b128 v4, v[24:27] offset:2048
  ds_write_b128 v4, v[28:31] offset:3072
  s_sub_u32 s54, s30, 6
  s_lshl_b32 s54, s54, 2
  s_add_u32 s54, s54, 512
  v_mov_b32 v4, s54
  v_mov_b32 v5, 1
  ds_write_b32 v4, v5
  s_branch A_kvp_done
A_kv5:
  v_mov_b32 v4, 512
  s_mov_b32 s56, 200063
A_kvspin:
  ds_read_b64 v[6:7], v4
  s_waitcnt lgkmcnt(0)
  v_and_b32 v6, v6, v7
  s_nop 0
  v_readfirstlane_b32 s54, v6
  s_sub_u32 s56, s56, 1
  s_cmp_eq_u32 s56, 0
  s_cbranch_scc1 A_kvspin_done
  s_cmp_eq_u32 s54, 1
  s_cbranch_scc1 A_kvspin_done
  s_sleep 1
  s_branch A_kvspin
A_kvspin_done:
  v_add_u32 v4, 67072, v15
  ds_read_b128 v[32:35], v4 offset:0
  ds_read_b128 v[36:39], v4 offset:1024
  ds_read_b128 v[40:43], v4 offset:2048
  ds_read_b128 v[44:47], v4 offset:3072
  ds_read_b128 v[48:51], v4 offset:4096
  ds_read_b128 v[52:55], v4 offset:5120
  ds_read_b128 v[56:59], v4 offset:6144
  ds_read_b128 v[60:63], v4 offset:7168
  s_waitcnt lgkmcnt(0)
  v_add_f32 v32, v32, v48
  v_add_f32 v33, v33, v49
  v_add_f32 v34, v34, v50
  v_add_f32 v35, v35, v51
  v_add_f32 v36, v36, v52
  v_add_f32 v37, v37, v53
  v_add_f32 v38, v38, v54
  v_add_f32 v39, v39, v55
  v_add_f32 v40, v40, v56
  v_add_f32 v41, v41, v57
  v_add_f32 v42, v42, v58
  v_add_f32 v43, v43, v59
  v_add_f32 v44, v44, v60
  v_add_f32 v45, v45, v61
  v_add_f32 v46, v46, v62
  v_add_f32 v47, v47, v63
  v_add_f32 v16, v16, v32
  v_add_f32 v17, v17, v33
  v_add_f32 v18, v18, v34
  v_add_f32 v19, v19, v35
  v_add_f32 v20, v20, v36
  v_add_f32 v21, v21, v37
  v_add_f32 v22, v22, v38
  v_add_f32 v23, v23, v39
  v_add_f32 v24, v24, v40
  v_add_f32 v25, v25, v41
  v_add_f32 v26, v26, v42
  v_add_f32 v27, v27, v43
  v_add_f32 v28, v28, v44
  v_add_f32 v29, v29, v45
  v_add_f32 v30, v30, v46
  v_add_f32 v31, v31, v47
  v_mul_f32 v16, v16, v9
  v_mul_f32 v17, v17, v9
  v_mul_f32 v18, v18, v9
  v_mul_f32 v19, v19, v9
  v_mul_f32 v20, v20, v9
  v_mul_f32 v21, v21, v9
  v_mul_f32 v22, v22, v9
  v_mul_f32 v23, v23, v9
  v_mul_f32 v24, v24, v9
  v_mul_f32 v25, v25, v9
  v_mul_f32 v26, v26, v9
  v_mul_f32 v27, v27, v9
  v_mul_f32 v28, v28, v9
  v_mul_f32 v29, v29, v9
  v_mul_f32 v30, v30, v9
  v_mul_f32 v31, v31, v9
  v_cmp_eq_u32 vcc, 1, v2
  v_mov_b32 v4, 1.0
  v_mov_b32 v5, 0
  v_cndmask_b32 v24, v24, v4, vcc
  v_cndmask_b32 v25, v25, v5, vcc
  v_cndmask_b32 v26, v26, v5, vcc
  v_cndmask_b32 v27, v27, v5, vcc
  v_mov_b32 v28, 0
  v_mov_b32 v29, 0
  v_mov_b32 v30, 0
  v_mov_b32 v31, 0
  v_cvt_pk_bf16_f32 v36, v16, v17
  v_cvt_pk_bf16_f32 v37, v18, v19
  v_cvt_pk_bf16_f32 v38, v20, v21
  v_cvt_pk_bf16_f32 v39, v22, v23
  v_cvt_pk_bf16_f32 v40, v24, v25
  v_cvt_pk_bf16_f32 v41, v26, v27
  v_cvt_pk_bf16_f32 v42, v28, v29
  v_cvt_pk_bf16_f32 v43, v30, v31
  s_mul_i32 s54, s52, 2688
  s_add_u32 s54, s54, 2686976
  s_cmp_eq_u32 s53, 1
  s_cbranch_scc1 A_v
  buffer_store_dwordx4 v[36:39], v15, s[32:35], s54 offen sc1
  v_lshlrev_b32 v4, 3, v1
  s_mov_b32 exec_hi, 0
  buffer_store_dwordx2 v[40:41], v4, s[32:35], s54 offen offset:1024 sc1
  s_mov_b32 exec_hi, -1
  s_branch A_kvdone
A_v:
  s_mov_b32 s59, 67072
  v_lshlrev_b32 v4, 6, v3
  v_lshl_add_u32 v4, v2, 3, v4
  v_add_u32 v4, s59, v4
  ds_write_b64 v4, v[36:37] offset:0
  ds_write_b64 v4, v[38:39] offset:16
  ds_write_b64 v4, v[40:41] offset:32
  ds_write_b64 v4, v[42:43] offset:48
  v_bfe_u32 v5, v1, 2, 2
  v_mul_u32_u24 v6, 4, v2
  v_add_u32 v5, v5, v6
  v_bfe_u32 v6, v1, 4, 1
  v_and_b32 v7, 3, v1
  v_lshlrev_b32 v7, 3, v7
  v_lshl_add_u32 v6, v6, 5, v7
  v_mul_u32_u24 v13, 64, v5
  v_add3_u32 v13, v13, v6, s59
  ds_read_b64_tr_b16 v[44:45], v13 offset:0
  ds_read_b64_tr_b16 v[46:47], v13 offset:512
  ds_read_b64_tr_b16 v[48:49], v13 offset:1024
  ds_read_b64_tr_b16 v[50:51], v13 offset:1536
  v_mul_u32_u24 v4, 352, v2
  v_lshl_add_u32 v4, v3, 4, v4
  s_mov_b32 exec_lo, 0x3fffff
  s_mov_b32 exec_hi, 0x3fffff
  s_waitcnt lgkmcnt(0)
  buffer_store_dwordx4 v[44:47], v4, s[32:35], s54 offen offset:1280 sc1
  buffer_store_dwordx4 v[48:51], v4, s[32:35], s54 offen offset:1984 sc1
  s_mov_b64 exec, -1
A_kvdone:
  s_mov_b32 s56, 200063
  v_mov_b32 v4, 0
  s_cmp_lg_u32 s31, 0
  s_cbranch_scc1 A5_tag_val
A5_tag:
  global_load_dword v5, v4, s[26:27] sc1
  s_waitcnt vmcnt(0)
  v_readfirstlane_b32 s31, v5
  s_sub_u32 s56, s56, 1
  s_cmp_eq_u32 s56, 0
  s_cbranch_scc1 A5_tag_done
  s_cmp_eq_u32 s31, 0
  s_cbranch_scc0 A5_tag_val
  s_and_b32 s62, s56, 31
  s_cmp_eq_u32 s62, 0
  s_cbranch_scc1 A5_tag_atom
  s_sleep 1
  s_branch A5_tag
A5_tag_val:
  s_memrealtime s[62:63]
  s_waitcnt lgkmcnt(0)
  s_sub_u32 s62, s62, s31
  s_cmp_lt_u32 s62, 2000
  s_cbranch_scc1 A5_tag_done
A5_tag_atom:
  s_mov_b64 s[62:63], exec
  s_mov_b64 exec, 1
  v_mov_b32 v5, 0
  global_atomic_add v5, v4, v5, s[26:27] sc0 sc1
  s_mov_b64 exec, s[62:63]
  s_waitcnt vmcnt(0)
  v_readfirstlane_b32 s31, v5
  s_cmp_eq_u32 s31, 0
  s_cbranch_scc0 A5_tag_done
  s_sub_u32 s56, s56, 1
  s_cmp_eq_u32 s56, 0
  s_cbranch_scc1 A5_tag_done
  s_sleep 1
  s_branch A5_tag
A5_tag_done:
  s_waitcnt vmcnt(0)
  s_lshl_b32 s54, s52, 1
  s_add_u32 s54, s54, s53
  v_mov_b32 v4, s31
  v_mov_b32 v5, 0
  s_lshl_b32 s63, s54, 7
  s_mov_b64 s[100:101], exec
  s_mov_b64 exec, 1
  buffer_store_dword v4, v5, s[36:39], s63 offen sc1
  s_mov_b64 exec, s[100:101]
  s_mov_b32 s59, 57856
  v_bfe_u32 v4, v1, 2, 2
  v_mul_u32_u24 v5, 8, v2
  v_add_u32 v4, v4, v5
  v_bfe_u32 v5, v1, 4, 1
  v_and_b32 v6, 3, v1
  v_lshlrev_b32 v6, 3, v6
  v_lshl_add_u32 v5, v5, 5, v6
  v_mul_u32_u24 v13, 64, v4
  v_add3_u32 v13, v13, v5, s59
  v_add_u32 v14, 256, v13
  v_add_u32 v11, s59, v15
  s_sub_u32 s54, s30, 4
  s_mul_i32 s54, s54, 10560
  v_add_u32 v12, s54, v10
  s_waitcnt vmcnt(10)
  ds_write_b128 v11, v[84:87] offset:0
  s_waitcnt vmcnt(9)
  ds_write_b128 v11, v[88:91] offset:1024
  s_waitcnt vmcnt(8)
  ds_write_b128 v11, v[92:95] offset:2048
  ds_read_b64_tr_b16 v[32:33], v13 offset:0
  ds_read_b64_tr_b16 v[34:35], v14 offset:0
  ds_read_b128 v[36:39], v12 offset:0
  s_waitcnt vmcnt(7)
  ds_write_b128 v11, v[96:99] offset:0
  ds_read_b64_tr_b16 v[40:41], v13 offset:1024
  ds_read_b64_tr_b16 v[42:43], v14 offset:1024
  ds_read_b128 v[44:47], v12 offset:1056
  s_waitcnt vmcnt(6)
  ds_write_b128 v11, v[100:103] offset:1024
  ds_read_b64_tr_b16 v[48:49], v13 offset:2048
  ds_read_b64_tr_b16 v[50:51], v14 offset:2048
  ds_read_b128 v[52:55], v12 offset:2112
  s_waitcnt vmcnt(5)
  ds_write_b128 v11, v[104:107] offset:2048
  ds_read_b64_tr_b16 v[56:57], v13 offset:0
  ds_read_b64_tr_b16 v[58:59], v14 offset:0
  ds_read_b128 v[60:63], v12 offset:3168
  s_waitcnt lgkmcnt(12)
  v_mfma_f32_32x32x16_bf16 v[16:31], v[32:35], v[36:39], 0
  s_waitcnt vmcnt(4)
  ds_write_b128 v11, v[108:111] offset:0
  ds_read_b64_tr_b16 v[32:33], v13 offset:1024
  ds_read_b64_tr_b16 v[34:35], v14 offset:1024
  ds_read_b128 v[36:39], v12 offset:4224
  s_waitcnt lgkmcnt(12)
  v_mfma_f32_32x32x16_bf16 v[16:31], v[40:43], v[44:47], v[16:31]
  s_waitcnt vmcnt(3)
  ds_write_b128 v11, v[112:115] offset:1024
  ds_read_b64_tr_b16 v[40:41], v13 offset:2048
  ds_read_b64_tr_b16 v[42:43], v14 offset:2048
  ds_read_b128 v[44:47], v12 offset:5280
  s_waitcnt lgkmcnt(12)
  v_mfma_f32_32x32x16_bf16 v[16:31], v[48:51], v[52:55], v[16:31]
  s_waitcnt vmcnt(2)
  ds_write_b128 v11, v[116:119] offset:2048
  ds_read_b64_tr_b16 v[48:49], v13 offset:0
  ds_read_b64_tr_b16 v[50:51], v14 offset:0
  ds_read_b128 v[52:55], v12 offset:6336
  s_waitcnt lgkmcnt(12)
  v_mfma_f32_32x32x16_bf16 v[16:31], v[56:59], v[60:63], v[16:31]
  s_waitcnt vmcnt(1)
  ds_write_b128 v11, v[120:123] offset:0
  ds_read_b64_tr_b16 v[56:57], v13 offset:1024
  ds_read_b64_tr_b16 v[58:59], v14 offset:1024
  ds_read_b128 v[60:63], v12 offset:7392
  s_waitcnt lgkmcnt(12)
  v_mfma_f32_32x32x16_bf16 v[16:31], v[32:35], v[36:39], v[16:31]
  ds_read_b64_tr_b16 v[32:33], v13 offset:2048
  ds_read_b64_tr_b16 v[34:35], v14 offset:2048
  ds_read_b128 v[36:39], v12 offset:8448
  s_waitcnt lgkmcnt(11)
  v_mfma_f32_32x32x16_bf16 v[16:31], v[40:43], v[44:47], v[16:31]
  ds_read_b64_tr_b16 v[40:41], v13 offset:0
  ds_read_b64_tr_b16 v[42:43], v14 offset:0
  ds_read_b128 v[44:47], v12 offset:9504
  s_waitcnt lgkmcnt(10)
  v_mfma_f32_32x32x16_bf16 v[16:31], v[48:51], v[52:55], v[16:31]
  s_waitcnt lgkmcnt(6)
  v_mfma_f32_32x32x16_bf16 v[16:31], v[56:59], v[60:63], v[16:31]
  s_waitcnt lgkmcnt(3)
  v_mfma_f32_32x32x16_bf16 v[16:31], v[32:35], v[36:39], v[16:31]
  s_waitcnt lgkmcnt(0)
  v_mfma_f32_32x32x16_bf16 v[16:31], v[40:43], v[44:47], v[16:31]
  s_waitcnt lgkmcnt(0)
  s_nop 11
  s_cmp_eq_u32 s30, 5
  s_cbranch_scc1 A_jp5_1
  ds_write_b128 v11, v[16:19] offset:0
  ds_write_b128 v11, v[20:23] offset:1024
  ds_write_b128 v11, v[24:27] offset:2048
  s_sub_u32 s54, s30, 6
  s_lshl_b32 s54, s54, 10
  s_add_u32 s54, s54, 75264
  v_add_u32 v4, s54, v15
  ds_write_b128 v4, v[28:31]
  s_branch A_jpd_2
A_jp5_1:
  v_add_u32 v4, 71168, v15
  ds_write_b128 v4, v[16:19] offset:0
  ds_write_b128 v4, v[20:23] offset:1024
  ds_write_b128 v4, v[24:27] offset:2048
  ds_write_b128 v4, v[28:31] offset:3072
A_jpd_2:
  s_sub_u32 s54, s30, 5
  s_lshl_b32 s54, s54, 2
  s_add_u32 s54, s54, 1040
  v_mov_b32 v4, s54
  v_mov_b32 v5, 1
  ds_write_b32 v4, v5
  s_branch A_bar1
A_kvp_skip:
  s_mov_b32 s44, s6
  s_mov_b32 s45, s7
  s_mov_b32 s46, 819200
  s_mov_b32 s47, 0x00020000
  v_lshrrev_b32 v4, 2, v1
  v_mul_u32_u24 v4, 1280, v4
  v_and_b32 v5, 3, v1
  v_lshl_add_u32 v4, v5, 4, v4
  s_mul_i32 s54, s53, 320
  s_add_u32 s54, s54, 256
  v_add_u32 v4, s54, v4
  s_sub_u32 s54, s30, 4
  s_mul_i32 s54, s54, 10
  s_mul_i32 s55, s60, 5
  s_add_u32 s54, s54, s55
  s_cmp_ge_u32 s54, 40
  s_cselect_b32 s55, 40, 0
  s_sub_u32 s54, s54, s55
  s_mul_i32 s58, s54, 20480
  s_add_u32 s54, s58, 20480
  buffer_load_dwordx4 v[84:87], v4, s[44:47], s58 offen
  s_cmp_eq_u32 s54, 819200
  s_cselect_b32 s58, 0, s54
  s_add_u32 s54, s58, 20480
  buffer_load_dwordx4 v[88:91], v4, s[44:47], s58 offen
  s_cmp_eq_u32 s54, 819200
  s_cselect_b32 s58, 0, s54
  s_add_u32 s54, s58, 20480
  buffer_load_dwordx4 v[92:95], v4, s[44:47], s58 offen
  s_cmp_eq_u32 s54, 819200
  s_cselect_b32 s58, 0, s54
  s_add_u32 s54, s58, 20480
  buffer_load_dwordx4 v[96:99], v4, s[44:47], s58 offen
  s_cmp_eq_u32 s54, 819200
  s_cselect_b32 s58, 0, s54
  s_add_u32 s54, s58, 20480
  buffer_load_dwordx4 v[100:103], v4, s[44:47], s58 offen
  s_cmp_eq_u32 s54, 819200
  s_cselect_b32 s58, 0, s54
  s_add_u32 s54, s58, 20480
  buffer_load_dwordx4 v[104:107], v4, s[44:47], s58 offen
  s_cmp_eq_u32 s54, 819200
  s_cselect_b32 s58, 0, s54
  s_add_u32 s54, s58, 20480
  buffer_load_dwordx4 v[108:111], v4, s[44:47], s58 offen
  s_cmp_eq_u32 s54, 819200
  s_cselect_b32 s58, 0, s54
  s_add_u32 s54, s58, 20480
  buffer_load_dwordx4 v[112:115], v4, s[44:47], s58 offen
  s_cmp_eq_u32 s54, 819200
  s_cselect_b32 s58, 0, s54
  s_add_u32 s54, s58, 20480
  buffer_load_dwordx4 v[116:119], v4, s[44:47], s58 offen
  s_cmp_eq_u32 s54, 819200
  s_cselect_b32 s58, 0, s54
  s_add_u32 s54, s58, 20480
  buffer_load_dwordx4 v[120:123], v4, s[44:47], s58 offen
  s_cmp_eq_u32 s54, 819200
  s_cselect_b32 s58, 0, s54
  s_cmp_lg_u32 s30, 5
  s_cbranch_scc1 A_kvp_done
  s_mov_b32 s59, 57856
  v_bfe_u32 v4, v1, 2, 2
  v_mul_u32_u24 v5, 8, v2
  v_add_u32 v4, v4, v5
  v_bfe_u32 v5, v1, 4, 1
  v_and_b32 v6, 3, v1
  v_lshlrev_b32 v6, 3, v6
  v_lshl_add_u32 v5, v5, 5, v6
  v_mul_u32_u24 v13, 64, v4
  v_add3_u32 v13, v13, v5, s59
  v_add_u32 v14, 256, v13
  v_add_u32 v11, s59, v15
  s_sub_u32 s54, s30, 4
  s_mul_i32 s54, s54, 10560
  v_add_u32 v12, s54, v10
  s_waitcnt vmcnt(9)
  ds_write_b128 v11, v[84:87] offset:0
  s_waitcnt vmcnt(8)
  ds_write_b128 v11, v[88:91] offset:1024
  s_waitcnt vmcnt(7)
  ds_write_b128 v11, v[92:95] offset:2048
  ds_read_b64_tr_b16 v[32:33], v13 offset:0
  ds_read_b64_tr_b16 v[34:35], v14 offset:0
  ds_read_b128 v[36:39], v12 offset:0
  s_waitcnt vmcnt(6)
  ds_write_b128 v11, v[96:99] offset:0
  ds_read_b64_tr_b16 v[40:41], v13 offset:1024
  ds_read_b64_tr_b16 v[42:43], v14 offset:1024
  ds_read_b128 v[44:47], v12 offset:1056
  s_waitcnt vmcnt(5)
  ds_write_b128 v11, v[100:103] offset:1024
  ds_read_b64_tr_b16 v[48:49], v13 offset:2048
  ds_read_b64_tr_b16 v[50:51], v14 offset:2048
  ds_read_b128 v[52:55], v12 offset:2112
  s_waitcnt vmcnt(4)
  ds_write_b128 v11, v[104:107] offset:2048
  ds_read_b64_tr_b16 v[56:57], v13 offset:0
  ds_read_b64_tr_b16 v[58:59], v14 offset:0
  ds_read_b128 v[60:63], v12 offset:3168
  s_waitcnt lgkmcnt(12)
  v_mfma_f32_32x32x16_bf16 v[16:31], v[32:35], v[36:39], 0
  s_waitcnt vmcnt(3)
  ds_write_b128 v11, v[108:111] offset:0
  ds_read_b64_tr_b16 v[32:33], v13 offset:1024
  ds_read_b64_tr_b16 v[34:35], v14 offset:1024
  ds_read_b128 v[36:39], v12 offset:4224
  s_waitcnt lgkmcnt(12)
  v_mfma_f32_32x32x16_bf16 v[16:31], v[40:43], v[44:47], v[16:31]
  s_waitcnt vmcnt(2)
  ds_write_b128 v11, v[112:115] offset:1024
  ds_read_b64_tr_b16 v[40:41], v13 offset:2048
  ds_read_b64_tr_b16 v[42:43], v14 offset:2048
  ds_read_b128 v[44:47], v12 offset:5280
  s_waitcnt lgkmcnt(12)
  v_mfma_f32_32x32x16_bf16 v[16:31], v[48:51], v[52:55], v[16:31]
  s_waitcnt vmcnt(1)
  ds_write_b128 v11, v[116:119] offset:2048
  ds_read_b64_tr_b16 v[48:49], v13 offset:0
  ds_read_b64_tr_b16 v[50:51], v14 offset:0
  ds_read_b128 v[52:55], v12 offset:6336
  s_waitcnt lgkmcnt(12)
  v_mfma_f32_32x32x16_bf16 v[16:31], v[56:59], v[60:63], v[16:31]
  s_waitcnt vmcnt(0)
  ds_write_b128 v11, v[120:123] offset:0
  ds_read_b64_tr_b16 v[56:57], v13 offset:1024
  ds_read_b64_tr_b16 v[58:59], v14 offset:1024
  ds_read_b128 v[60:63], v12 offset:7392
  s_waitcnt lgkmcnt(12)
  v_mfma_f32_32x32x16_bf16 v[16:31], v[32:35], v[36:39], v[16:31]
  ds_read_b64_tr_b16 v[32:33], v13 offset:2048
  ds_read_b64_tr_b16 v[34:35], v14 offset:2048
  ds_read_b128 v[36:39], v12 offset:8448
  s_waitcnt lgkmcnt(11)
  v_mfma_f32_32x32x16_bf16 v[16:31], v[40:43], v[44:47], v[16:31]
  ds_read_b64_tr_b16 v[40:41], v13 offset:0
  ds_read_b64_tr_b16 v[42:43], v14 offset:0
  ds_read_b128 v[44:47], v12 offset:9504
  s_waitcnt lgkmcnt(10)
  v_mfma_f32_32x32x16_bf16 v[16:31], v[48:51], v[52:55], v[16:31]
  s_waitcnt lgkmcnt(6)
  v_mfma_f32_32x32x16_bf16 v[16:31], v[56:59], v[60:63], v[16:31]
  s_waitcnt lgkmcnt(3)
  v_mfma_f32_32x32x16_bf16 v[16:31], v[32:35], v[36:39], v[16:31]
  s_waitcnt lgkmcnt(0)
  v_mfma_f32_32x32x16_bf16 v[16:31], v[40:43], v[44:47], v[16:31]
  s_waitcnt lgkmcnt(0)
  s_nop 11
  s_cmp_eq_u32 s30, 5
  s_cbranch_scc1 A_jp5_3
  ds_write_b128 v11, v[16:19] offset:0
  ds_write_b128 v11, v[20:23] offset:1024
  ds_write_b128 v11, v[24:27] offset:2048
  s_sub_u32 s54, s30, 6
  s_lshl_b32 s54, s54, 10
  s_add_u32 s54, s54, 75264
  v_add_u32 v4, s54, v15
  ds_write_b128 v4, v[28:31]
  s_branch A_jpd_4
A_jp5_3:
  v_add_u32 v4, 71168, v15
  ds_write_b128 v4, v[16:19] offset:0
  ds_write_b128 v4, v[20:23] offset:1024
  ds_write_b128 v4, v[24:27] offset:2048
  ds_write_b128 v4, v[28:31] offset:3072
A_jpd_4:
  s_sub_u32 s54, s30, 5
  s_lshl_b32 s54, s54, 2
  s_add_u32 s54, s54, 1040
  v_mov_b32 v4, s54
  v_mov_b32 v5, 1
  ds_write_b32 v4, v5
  s_branch A_bar1
A_kvp_done:
  s_mul_i32 s54, s53, 2
  s_add_u32 s54, s54, s30
  s_sub_u32 s54, s54, 6
  s_sub_u32 s55, s54, s60
  s_and_b32 s55, s55, 7
  s_mul_i32 s55, s55, 5280
  v_add_u32 v4, s55, v10
  ds_read_b128 v[16:19], v4 offset:0
  ds_read_b128 v[20:23], v4 offset:1056
  ds_read_b128 v[24:27], v4 offset:2112
  ds_read_b128 v[28:31], v4 offset:3168
  ds_read_b128 v[32:35], v4 offset:4224
  s_mul_i32 s55, s52, 40
  s_mul_i32 s95, s54, 5
  s_add_u32 s55, s55, s95
  s_lshl_b32 s55, s55, 10
  s_lshl_b32 s94, s52, 3
  s_add_u32 s94, s94, s54
  v_add_u32 v5, 4096, v15
  s_waitcnt lgkmcnt(0)
  buffer_store_dwordx4 v[16:19], v15, s[32:35], s55 offen offset:0 sc1
  buffer_store_dwordx4 v[20:23], v15, s[32:35], s55 offen offset:1024 sc1
  buffer_store_dwordx4 v[24:27], v15, s[32:35], s55 offen offset:2048 sc1
  buffer_store_dwordx4 v[28:31], v15, s[32:35], s55 offen offset:3072 sc1
  buffer_store_dwordx4 v[32:35], v5, s[32:35], s55 offen sc1
  s_cmp_lg_u32 s54, 0
  s_cbranch_scc1 A_nor
  s_lshl_b32 s55, s52, 7
  s_add_u32 s55, s55, 2621440
  v_lshlrev_b32 v4, 2, v3
  buffer_store_dword v9, v4, s[32:35], s55 offen sc1
A_nor:
  s_mov_b32 s56, 200063
  v_mov_b32 v4, 0
  s_cmp_lg_u32 s31, 0
  s_cbranch_scc1 A6_tag_val
A6_tag:
  global_load_dword v5, v4, s[26:27] sc1
  s_waitcnt vmcnt(0)
  v_readfirstlane_b32 s31, v5
  s_sub_u32 s56, s56, 1
  s_cmp_eq_u32 s56, 0
  s_cbranch_scc1 A6_tag_done
  s_cmp_eq_u32 s31, 0
  s_cbranch_scc0 A6_tag_val
  s_and_b32 s62, s56, 31
  s_cmp_eq_u32 s62, 0
  s_cbranch_scc1 A6_tag_atom
  s_sleep 1
  s_branch A6_tag
A6_tag_val:
  s_memrealtime s[62:63]
  s_waitcnt lgkmcnt(0)
  s_sub_u32 s62, s62, s31
  s_cmp_lt_u32 s62, 2000
  s_cbranch_scc1 A6_tag_done
A6_tag_atom:
  s_mov_b64 s[62:63], exec
  s_mov_b64 exec, 1
  v_mov_b32 v5, 0
  global_atomic_add v5, v4, v5, s[26:27] sc0 sc1
  s_mov_b64 exec, s[62:63]
  s_waitcnt vmcnt(0)
  v_readfirstlane_b32 s31, v5
  s_cmp_eq_u32 s31, 0
  s_cbranch_scc0 A6_tag_done
  s_sub_u32 s56, s56, 1
  s_cmp_eq_u32 s56, 0
  s_cbranch_scc1 A6_tag_done
  s_sleep 1
  s_branch A6_tag
A6_tag_done:
  v_mov_b32 v4, 81904
  v_mov_b32 v5, s31
  ds_write_b32 v4, v5
  s_waitcnt vmcnt(0)
  v_mov_b32 v4, s31
  v_mov_b32 v5, 0
  s_lshl_b32 s63, s94, 7
  s_add_u32 s63, s63, 16384
  s_mov_b64 s[100:101], exec
  s_mov_b64 exec, 1
  buffer_store_dword v4, v5, s[36:39], s63 offen sc1
  s_mov_b64 exec, s[100:101]
  s_sub_u32 s54, s30, 5
  s_mul_i32 s59, s54, 3072
  s_add_u32 s59, s59, 57856
  v_bfe_u32 v4, v1, 2, 2
  v_mul_u32_u24 v5, 8, v2
  v_add_u32 v4, v4, v5
  v_bfe_u32 v5, v1, 4, 1
  v_and_b32 v6, 3, v1
  v_lshlrev_b32 v6, 3, v6
  v_lshl_add_u32 v5, v5, 5, v6
  v_mul_u32_u24 v13, 64, v4
  v_add3_u32 v13, v13, v5, s59
  v_add_u32 v14, 256, v13
  v_add_u32 v11, s59, v15
  s_sub_u32 s54, s30, 4
  s_mul_i32 s54, s54, 10560
  v_add_u32 v12, s54, v10
  s_waitcnt vmcnt(10)
  ds_write_b128 v11, v[84:87] offset:0
  s_waitcnt vmcnt(9)
  ds_write_b128 v11, v[88:91] offset:1024
  s_waitcnt vmcnt(8)
  ds_write_b128 v11, v[92:95] offset:2048
  ds_read_b64_tr_b16 v[32:33], v13 offset:0
  ds_read_b64_tr_b16 v[34:35], v14 offset:0
  ds_read_b128 v[36:39], v12 offset:0
  s_waitcnt vmcnt(7)
  ds_write_b128 v11, v[96:99] offset:0
  ds_read_b64_tr_b16 v[40:41], v13 offset:1024
  ds_read_b64_tr_b16 v[42:43], v14 offset:1024
  ds_read_b128 v[44:47], v12 offset:1056
  s_waitcnt vmcnt(6)
  ds_write_b128 v11, v[100:103] offset:1024
  ds_read_b64_tr_b16 v[48:49], v13 offset:2048
  ds_read_b64_tr_b16 v[50:51], v14 offset:2048
  ds_read_b128 v[52:55], v12 offset:2112
  s_waitcnt vmcnt(5)
  ds_write_b128 v11, v[104:107] offset:2048
  ds_read_b64_tr_b16 v[56:57], v13 offset:0
  ds_read_b64_tr_b16 v[58:59], v14 offset:0
  ds_read_b128 v[60:63], v12 offset:3168
  s_waitcnt lgkmcnt(12)
  v_mfma_f32_32x32x16_bf16 v[16:31], v[32:35], v[36:39], 0
  s_waitcnt vmcnt(4)
  ds_write_b128 v11, v[108:111] offset:0
  ds_read_b64_tr_b16 v[32:33], v13 offset:1024
  ds_read_b64_tr_b16 v[34:35], v14 offset:1024
  ds_read_b128 v[36:39], v12 offset:4224
  s_waitcnt lgkmcnt(12)
  v_mfma_f32_32x32x16_bf16 v[16:31], v[40:43], v[44:47], v[16:31]
  s_waitcnt vmcnt(3)
  ds_write_b128 v11, v[112:115] offset:1024
  ds_read_b64_tr_b16 v[40:41], v13 offset:2048
  ds_read_b64_tr_b16 v[42:43], v14 offset:2048
  ds_read_b128 v[44:47], v12 offset:5280
  s_waitcnt lgkmcnt(12)
  v_mfma_f32_32x32x16_bf16 v[16:31], v[48:51], v[52:55], v[16:31]
  s_waitcnt vmcnt(2)
  ds_write_b128 v11, v[116:119] offset:2048
  ds_read_b64_tr_b16 v[48:49], v13 offset:0
  ds_read_b64_tr_b16 v[50:51], v14 offset:0
  ds_read_b128 v[52:55], v12 offset:6336
  s_waitcnt lgkmcnt(12)
  v_mfma_f32_32x32x16_bf16 v[16:31], v[56:59], v[60:63], v[16:31]
  s_waitcnt vmcnt(1)
  ds_write_b128 v11, v[120:123] offset:0
  ds_read_b64_tr_b16 v[56:57], v13 offset:1024
  ds_read_b64_tr_b16 v[58:59], v14 offset:1024
  ds_read_b128 v[60:63], v12 offset:7392
  s_waitcnt lgkmcnt(12)
  v_mfma_f32_32x32x16_bf16 v[16:31], v[32:35], v[36:39], v[16:31]
  ds_read_b64_tr_b16 v[32:33], v13 offset:2048
  ds_read_b64_tr_b16 v[34:35], v14 offset:2048
  ds_read_b128 v[36:39], v12 offset:8448
  s_waitcnt lgkmcnt(11)
  v_mfma_f32_32x32x16_bf16 v[16:31], v[40:43], v[44:47], v[16:31]
  ds_read_b64_tr_b16 v[40:41], v13 offset:0
  ds_read_b64_tr_b16 v[42:43], v14 offset:0
  ds_read_b128 v[44:47], v12 offset:9504
  s_waitcnt lgkmcnt(10)
  v_mfma_f32_32x32x16_bf16 v[16:31], v[48:51], v[52:55], v[16:31]
  s_waitcnt lgkmcnt(6)
  v_mfma_f32_32x32x16_bf16 v[16:31], v[56:59], v[60:63], v[16:31]
  s_waitcnt lgkmcnt(3)
  v_mfma_f32_32x32x16_bf16 v[16:31], v[32:35], v[36:39], v[16:31]
  s_waitcnt lgkmcnt(0)
  v_mfma_f32_32x32x16_bf16 v[16:31], v[40:43], v[44:47], v[16:31]
  s_waitcnt lgkmcnt(0)
  s_nop 11
  s_cmp_eq_u32 s30, 5
  s_cbranch_scc1 A_jp5_5
  ds_write_b128 v11, v[16:19] offset:0
  ds_write_b128 v11, v[20:23] offset:1024
  ds_write_b128 v11, v[24:27] offset:2048
  s_sub_u32 s54, s30, 6
  s_lshl_b32 s54, s54, 10
  s_add_u32 s54, s54, 75264
  v_add_u32 v4, s54, v15
  ds_write_b128 v4, v[28:31]
  s_branch A_jpd_6
A_jp5_5:
  v_add_u32 v4, 71168, v15
  ds_write_b128 v4, v[16:19] offset:0
  ds_write_b128 v4, v[20:23] offset:1024
  ds_write_b128 v4, v[24:27] offset:2048
  ds_write_b128 v4, v[28:31] offset:3072
A_jpd_6:
  s_sub_u32 s54, s30, 5
  s_lshl_b32 s54, s54, 2
  s_add_u32 s54, s54, 1040
  v_mov_b32 v4, s54
  v_mov_b32 v5, 1
  ds_write_b32 v4, v5
A_bar1:
  s_waitcnt vmcnt(0)
A_bar1_nowait:
  s_setprio 0
  s_waitcnt lgkmcnt(0)
  s_barrier
  s_add_u32 s40, s28, 2686976
  s_addc_u32 s41, s29, 0
  s_mov_b32 s42, 172032
  s_mov_b32 s43, 0x00020000
  s_lshl_b32 s59, s30, 10
  v_lshlrev_b32 v70, 3, v3
  v_add_u32 v70, 1024, v70
  v_mov_b32 v4, 1616
  v_cmp_eq_u32 vcc, 1, v2
  v_min_u32 v71, 21, v3
  v_lshlrev_b32 v71, 4, v71
  v_cndmask_b32 v70, v70, v4, vcc
  v_mul_u32_u24 v4, 352, v2
  v_add3_u32 v71, v71, v4, 0
  v_add_u32 v71, 1280, v71
  v_mul_u32_u24 v4, 328, v3
  v_add_u32 v4, 65536, v4
  s_cmp_ge_u32 s30, 5
  s_cbranch_scc1 A_noqw
  s_lshl_b32 s54, s30, 6
  v_lshl_add_u32 v5, v2, 3, v4
  v_add_u32 v5, s54, v5
  ds_write_b64 v5, v[36:37] offset:0
  ds_write_b64 v5, v[38:39] offset:16
  ds_write_b64 v5, v[40:41] offset:32
  ds_write_b64 v5, v[42:43] offset:48
A_noqw:
  s_waitcnt lgkmcnt(0)
  s_barrier
  s_mul_i32 s54, s30, 40
  v_add_u32 v4, s54, v4
  v_lshl_add_u32 v5, v2, 3, v4
  ds_read_b64 v[104:105], v5
  ds_read_b64 v[106:107], v5 offset:16
  ds_read_b64 v[108:109], v4 offset:32
  v_mov_b32 v64, v15
  v_mov_b32 v65, v70
  v_mov_b32 v66, v71
  v_add_u32 v67, 21504, v15
  v_add_u32 v68, 21504, v70
  v_add_u32 v69, 21504, v71
  v_mov_b32 v48, 0
  v_mov_b32 v49, 0
  v_mov_b32 v50, 0
  v_mov_b32 v51, 0
  v_mov_b32 v52, 0
  v_mov_b32 v53, 0
  v_mov_b32 v54, 0
  v_mov_b32 v55, 0
  v_mov_b32 v56, 0
  v_mov_b32 v57, 0
  v_mov_b32 v58, 0
  v_mov_b32 v59, 0
  v_mov_b32 v60, 0
  v_mov_b32 v61, 0
  v_mov_b32 v62, 0
  v_mov_b32 v63, 0
  v_cmp_eq_u32 vcc, 1, v2
  v_mov_b32 v4, 0
  s_waitcnt lgkmcnt(0)
  v_cndmask_b32 v108, v108, v4, vcc
  v_cndmask_b32 v109, v109, v4, vcc
  s_lshr_b32 s61, s52, 3
  s_mul_i32 s58, s61, 21504
  s_cmp_lg_u32 s30, 7
  s_cbranch_scc1 A7a_skip
  s_lshl_b32 s54, s61, 4
  v_lshlrev_b32 v6, 7, v1
  s_lshl_b32 s63, s54, 7
  s_mov_b32 s56, 200063
  s_mov_b64 s[100:101], exec
  s_mov_b32 exec_lo, 65535
  s_mov_b32 exec_hi, 0
A7a_poll:
  s_and_b32 s62, s56, 63
  s_cmp_eq_u32 s62, 0
  s_cbranch_scc1 A7a_poll_atom
  buffer_load_dword v7, v6, s[36:39], s63 offen sc1
  s_branch A7a_poll_got
A7a_poll_atom:
  v_mov_b32 v7, 0
  buffer_atomic_add v7, v6, s[36:39], s63 offen sc0 sc1
A7a_poll_got:
  s_waitcnt vmcnt(0)
  v_cmp_ne_u32 vcc, s31, v7
  s_nop 1
  s_and_b64 exec, exec, vcc
  s_cbranch_execz A7a_poll_done
  s_sub_u32 s56, s56, 1
  s_cmp_eq_u32 s56, 0
  s_cbranch_scc1 A7a_poll_done
  s_sleep 1
  s_branch A7a_poll
A7a_poll_done:
  s_mov_b64 exec, s[100:101]
A7a_skip:
  s_barrier
  s_mov_b32 s60, 0
  s_cmp_ge_u32 s30, 4
  s_cbranch_scc1 A_dm_7
  s_add_u32 s54, s60, s59
  s_add_u32 s55, s58, s59
  s_add_u32 m0, s54, 0
  s_add_u32 s56, s55, 0
  buffer_load_dwordx4 v15, s[40:43], s56 offen sc1 lds
  s_add_u32 m0, s54, 4096
  s_add_u32 s56, s55, 4096
  buffer_load_dwordx4 v15, s[40:43], s56 offen sc1 lds
  s_add_u32 m0, s54, 8192
  s_add_u32 s56, s55, 8192
  buffer_load_dwordx4 v15, s[40:43], s56 offen sc1 lds
  s_add_u32 m0, s54, 12288
  s_add_u32 s56, s55, 12288
  buffer_load_dwordx4 v15, s[40:43], s56 offen sc1 lds
  s_add_u32 m0, s54, 16384
  s_add_u32 s56, s55, 16384
  buffer_load_dwordx4 v15, s[40:43], s56 offen sc1 lds
  s_cmp_lg_u32 s30, 0
  s_cbranch_scc1 A_dm_7
  s_add_u32 m0, s54, 20480
  s_add_u32 s56, s55, 20480
  buffer_load_dwordx4 v15, s[40:43], s56 offen sc1 lds
A_dm_7:
  s_add_u32 s58, s58, 21504
  s_cmp_eq_u32 s58, 172032
  s_cselect_b32 s58, 0, s58
  s_add_u32 s61, s61, 1
  s_and_b32 s61, s61, 7
  v_min_u32 v73, 15, v1
  v_lshlrev_b32 v73, 7, v73
  s_waitcnt vmcnt(0)
  s_barrier
  ds_read_b128 v[112:115], v64 offset:0
  ds_read_b64 v[116:117], v65 offset:0
  v_mov_b32 v110, 0xff800000
  s_waitcnt lgkmcnt(0)
  v_mfma_f32_32x32x16_bf16 v[16:31], v[112:115], v[104:107], 0
  v_mfma_f32_32x32x8_bf16 v[16:31], v[116:117], v[108:109], v[16:31]
  ds_read_b128 v[112:115], v64 offset:2688
  ds_read_b64 v[116:117], v65 offset:2688
  s_waitcnt lgkmcnt(0)
  v_mfma_f32_32x32x16_bf16 v[32:47], v[112:115], v[104:107], 0
  v_mfma_f32_32x32x8_bf16 v[32:47], v[116:117], v[108:109], v[32:47]
  ds_read_b128 v[112:115], v64 offset:0
  ds_read_b64 v[116:117], v65 offset:0
  v_mov_b32 v100, 0
  v_mov_b32 v101, 0
  v_mov_b32 v102, 0
  v_mov_b32 v103, 0
  v_mov_b32 v124, 0
  v_mov_b32 v125, 0
  v_mov_b32 v126, 0
  v_mov_b32 v127, 0
  s_nop 3
  v_max3_f32 v110, v16, v17, v110
  v_max3_f32 v110, v18, v19, v110
  v_max3_f32 v110, v20, v21, v110
  v_max3_f32 v110, v22, v23, v110
  v_max3_f32 v110, v24, v25, v110
  v_max3_f32 v110, v26, v27, v110
  v_max3_f32 v110, v28, v29, v110
  v_max3_f32 v110, v30, v31, v110
  s_nop 3
  v_max3_f32 v110, v32, v33, v110
  v_max3_f32 v110, v34, v35, v110
  v_max3_f32 v110, v36, v37, v110
  v_max3_f32 v110, v38, v39, v110
  v_max3_f32 v110, v40, v41, v110
  v_max3_f32 v110, v42, v43, v110
  v_max3_f32 v110, v44, v45, v110
  v_max3_f32 v110, v46, v47, v110
  v_mov_b32 v4, v110
  s_nop 1
  v_permlane32_swap_b32 v110, v4
  s_nop 0
  v_max_f32 v110, v110, v4
  v_add_f32 v110, 1119879168, v110
  v_sub_f32 v80, 0, v110
  v_sub_f32 v81, 0, v110
  v_sub_f32 v82, 0, v110
  v_sub_f32 v83, 0, v110
  v_sub_f32 v84, 0, v110
  v_sub_f32 v85, 0, v110
  v_sub_f32 v86, 0, v110
  v_sub_f32 v87, 0, v110
  v_sub_f32 v88, 0, v110
  v_sub_f32 v89, 0, v110
  v_sub_f32 v90, 0, v110
  v_sub_f32 v91, 0, v110
  v_sub_f32 v92, 0, v110
  v_sub_f32 v93, 0, v110
  v_sub_f32 v94, 0, v110
  v_sub_f32 v95, 0, v110
  s_waitcnt lgkmcnt(0)
  s_nop 0
  v_mfma_f32_32x32x16_bf16 v[16:31], v[112:115], v[104:107], v[80:95]
  v_mfma_f32_32x32x8_bf16 v[16:31], v[116:117], v[108:109], v[16:31]
  ds_read_b128 v[112:115], v64 offset:2688
  ds_read_b64 v[116:117], v65 offset:2688
  ds_read_b128 v[120:123], v66 offset:0
  s_cmp_lg_u32 s30, 7
  s_cbranch_scc1 A7b_skip
  s_lshl_b32 s54, s61, 4
  v_lshlrev_b32 v6, 7, v1
  s_lshl_b32 s63, s54, 7
  s_mov_b32 s56, 200063
  s_mov_b64 s[100:101], exec
  s_mov_b32 exec_lo, 65535
  s_mov_b32 exec_hi, 0
A7b_poll:
  s_and_b32 s62, s56, 63
  s_cmp_eq_u32 s62, 0
  s_cbranch_scc1 A7b_poll_atom
  buffer_load_dword v7, v6, s[36:39], s63 offen sc1
  s_branch A7b_poll_got
A7b_poll_atom:
  v_mov_b32 v7, 0
  buffer_atomic_add v7, v6, s[36:39], s63 offen sc0 sc1
A7b_poll_got:
  s_waitcnt vmcnt(0)
  v_cmp_ne_u32 vcc, s31, v7
  s_nop 1
  s_and_b64 exec, exec, vcc
  s_cbranch_execz A7b_poll_done
  s_sub_u32 s56, s56, 1
  s_cmp_eq_u32 s56, 0
  s_cbranch_scc1 A7b_poll_done
  s_sleep 1
  s_branch A7b_poll
A7b_poll_done:
  s_mov_b64 exec, s[100:101]
A7b_skip:
  s_barrier
  s_mov_b32 s60, 21504
  s_cmp_ge_u32 s30, 4
  s_cbranch_scc1 A_dm_8
  s_add_u32 s54, s60, s59
  s_add_u32 s55, s58, s59
  s_add_u32 m0, s54, 0
  s_add_u32 s56, s55, 0
  buffer_load_dwordx4 v15, s[40:43], s56 offen sc1 lds
  s_add_u32 m0, s54, 4096
  s_add_u32 s56, s55, 4096
  buffer_load_dwordx4 v15, s[40:43], s56 offen sc1 lds
  s_add_u32 m0, s54, 8192
  s_add_u32 s56, s55, 8192
  buffer_load_dwordx4 v15, s[40:43], s56 offen sc1 lds
  s_add_u32 m0, s54, 12288
  s_add_u32 s56, s55, 12288
  buffer_load_dwordx4 v15, s[40:43], s56 offen sc1 lds
  s_add_u32 m0, s54, 16384
  s_add_u32 s56, s55, 16384
  buffer_load_dwordx4 v15, s[40:43], s56 offen sc1 lds
  s_cmp_lg_u32 s30, 0
  s_cbranch_scc1 A_dm_8
  s_add_u32 m0, s54, 20480
  s_add_u32 s56, s55, 20480
  buffer_load_dwordx4 v15, s[40:43], s56 offen sc1 lds
A_dm_8:
  s_add_u32 s58, s58, 21504
  s_cmp_eq_u32 s58, 172032
  s_cselect_b32 s58, 0, s58
  s_add_u32 s61, s61, 1
  s_and_b32 s61, s61, 7
  s_mov_b32 s60, 43008
  s_nop 11
  s_setprio 0
  s_cmp_lt_u32 s30, 4
  s_cbranch_scc1 A_pr0
  s_setprio 1
A_pr0:
  s_mov_b32 s57, 0
  .p2align 6
A_loop:
  s_cmp_lg_u32 s30, 7
  s_cbranch_scc1 A_nf0
  s_lshl_b32 s54, s61, 11
  s_add_u32 s54, s54, 0
  buffer_load_dword v72, v73, s[36:39], s54 offen sc1
A_nf0:
  v_exp_f32 v16, v16
  v_exp_f32 v17, v17
  s_waitcnt lgkmcnt(2)
  v_mfma_f32_32x32x16_bf16 v[48:63], v[124:127], v[100:103], v[48:63]
  ds_read_b128 v[124:127], v66 offset:704
  v_exp_f32 v18, v18
  v_exp_f32 v19, v19
  v_cvt_pk_bf16_f32 v96, v16, v17
  v_cvt_pk_bf16_f32 v97, v18, v19
  v_mfma_f32_32x32x16_bf16 v[32:47], v[112:115], v[104:107], v[80:95]
  ds_read_b128 v[112:115], v64 offset:5376
  v_exp_f32 v20, v20
  v_exp_f32 v21, v21
  v_exp_f32 v22, v22
  v_exp_f32 v23, v23
  v_cvt_pk_bf16_f32 v98, v20, v21
  v_cvt_pk_bf16_f32 v99, v22, v23
  s_waitcnt lgkmcnt(2)
  v_mfma_f32_32x32x8_bf16 v[32:47], v[116:117], v[108:109], v[32:47]
  ds_read_b64 v[116:117], v65 offset:5376
  v_exp_f32 v24, v24
  v_exp_f32 v25, v25
  v_exp_f32 v26, v26
  v_exp_f32 v27, v27
  v_cvt_pk_bf16_f32 v100, v24, v25
  v_cvt_pk_bf16_f32 v101, v26, v27
  v_mfma_f32_32x32x16_bf16 v[48:63], v[120:123], v[96:99], v[48:63]
  ds_read_b128 v[120:123], v66 offset:2688
  v_exp_f32 v28, v28
  v_exp_f32 v29, v29
  v_exp_f32 v30, v30
  v_exp_f32 v31, v31
  v_cvt_pk_bf16_f32 v102, v28, v29
  v_cvt_pk_bf16_f32 v103, v30, v31
  v_exp_f32 v32, v32
  v_exp_f32 v33, v33
  s_waitcnt lgkmcnt(2)
  v_mfma_f32_32x32x16_bf16 v[48:63], v[124:127], v[100:103], v[48:63]
  ds_read_b128 v[124:127], v66 offset:3392
  v_exp_f32 v34, v34
  v_exp_f32 v35, v35
  v_cvt_pk_bf16_f32 v96, v32, v33
  v_cvt_pk_bf16_f32 v97, v34, v35
  v_mfma_f32_32x32x16_bf16 v[16:31], v[112:115], v[104:107], v[80:95]
  ds_read_b128 v[112:115], v64 offset:8064
  v_exp_f32 v36, v36
  v_exp_f32 v37, v37
  v_exp_f32 v38, v38
  v_exp_f32 v39, v39
  v_cvt_pk_bf16_f32 v98, v36, v37
  v_cvt_pk_bf16_f32 v99, v38, v39
  s_waitcnt lgkmcnt(2)
  v_mfma_f32_32x32x8_bf16 v[16:31], v[116:117], v[108:109], v[16:31]
  ds_read_b64 v[116:117], v65 offset:8064
  v_exp_f32 v40, v40
  v_exp_f32 v41, v41
  v_exp_f32 v42, v42
  v_exp_f32 v43, v43
  v_cvt_pk_bf16_f32 v100, v40, v41
  v_cvt_pk_bf16_f32 v101, v42, v43
  v_mfma_f32_32x32x16_bf16 v[48:63], v[120:123], v[96:99], v[48:63]
  ds_read_b128 v[120:123], v66 offset:5376
  v_exp_f32 v44, v44
  v_exp_f32 v45, v45
  v_exp_f32 v46, v46
  v_exp_f32 v47, v47
  v_cvt_pk_bf16_f32 v102, v44, v45
  v_cvt_pk_bf16_f32 v103, v46, v47
  v_exp_f32 v16, v16
  v_exp_f32 v17, v17
  s_waitcnt lgkmcnt(2)
  v_mfma_f32_32x32x16_bf16 v[48:63], v[124:127], v[100:103], v[48:63]
  ds_read_b128 v[124:127], v66 offset:6080
  v_exp_f32 v18, v18
  v_exp_f32 v19, v19
  v_cvt_pk_bf16_f32 v96, v16, v17
  v_cvt_pk_bf16_f32 v97, v18, v19
  v_mfma_f32_32x32x16_bf16 v[32:47], v[112:115], v[104:107], v[80:95]
  ds_read_b128 v[112:115], v64 offset:10752
  v_exp_f32 v20, v20
  v_exp_f32 v21, v21
  v_exp_f32 v22, v22
  v_exp_f32 v23, v23
  v_cvt_pk_bf16_f32 v98, v20, v21
  v_cvt_pk_bf16_f32 v99, v22, v23
  s_waitcnt lgkmcnt(2)
  v_mfma_f32_32x32x8_bf16 v[32:47], v[116:117], v[108:109], v[32:47]
  ds_read_b64 v[116:117], v65 offset:10752
  v_exp_f32 v24, v24
  v_exp_f32 v25, v25
  v_exp_f32 v26, v26
  v_exp_f32 v27, v27
  v_cvt_pk_bf16_f32 v100, v24, v25
  v_cvt_pk_bf16_f32 v101, v26, v27
  v_mfma_f32_32x32x16_bf16 v[48:63], v[120:123], v[96:99], v[48:63]
  ds_read_b128 v[120:123], v66 offset:8064
  v_exp_f32 v28, v28
  v_exp_f32 v29, v29
  v_exp_f32 v30, v30
  v_exp_f32 v31, v31
  v_cvt_pk_bf16_f32 v102, v28, v29
  v_cvt_pk_bf16_f32 v103, v30, v31
  v_exp_f32 v32, v32
  v_exp_f32 v33, v33
  s_waitcnt lgkmcnt(2)
  v_mfma_f32_32x32x16_bf16 v[48:63], v[124:127], v[100:103], v[48:63]
  ds_read_b128 v[124:127], v66 offset:8768
  v_exp_f32 v34, v34
  v_exp_f32 v35, v35
  v_cvt_pk_bf16_f32 v96, v32, v33
  v_cvt_pk_bf16_f32 v97, v34, v35
  v_mfma_f32_32x32x16_bf16 v[16:31], v[112:115], v[104:107], v[80:95]
  ds_read_b128 v[112:115], v64 offset:13440
  v_exp_f32 v36, v36
  v_exp_f32 v37, v37
  v_exp_f32 v38, v38
  v_exp_f32 v39, v39
  v_cvt_pk_bf16_f32 v98, v36, v37
  v_cvt_pk_bf16_f32 v99, v38, v39
  s_waitcnt lgkmcnt(2)
  v_mfma_f32_32x32x8_bf16 v[16:31], v[116:117], v[108:109], v[16:31]
  ds_read_b64 v[116:117], v65 offset:13440
  v_exp_f32 v40, v40
  v_exp_f32 v41, v41
  v_exp_f32 v42, v42
  v_exp_f32 v43, v43
  v_cvt_pk_bf16_f32 v100, v40, v41
  v_cvt_pk_bf16_f32 v101, v42, v43
  v_mfma_f32_32x32x16_bf16 v[48:63], v[120:123], v[96:99], v[48:63]
  ds_read_b128 v[120:123], v66 offset:10752
  v_exp_f32 v44, v44
  v_exp_f32 v45, v45
  v_exp_f32 v46, v46
  v_exp_f32 v47, v47
  v_cvt_pk_bf16_f32 v102, v44, v45
  v_cvt_pk_bf16_f32 v103, v46, v47
  s_setprio 0
  v_exp_f32 v16, v16
  v_exp_f32 v17, v17
  s_waitcnt lgkmcnt(2)
  v_mfma_f32_32x32x16_bf16 v[48:63], v[124:127], v[100:103], v[48:63]
  ds_read_b128 v[124:127], v66 offset:11456
  v_exp_f32 v18, v18
  v_exp_f32 v19, v19
  v_cvt_pk_bf16_f32 v96, v16, v17
  v_cvt_pk_bf16_f32 v97, v18, v19
  v_mfma_f32_32x32x16_bf16 v[32:47], v[112:115], v[104:107], v[80:95]
  ds_read_b128 v[112:115], v64 offset:16128
  v_exp_f32 v20, v20
  v_exp_f32 v21, v21
  v_exp_f32 v22, v22
  v_exp_f32 v23, v23
  v_cvt_pk_bf16_f32 v98, v20, v21
  v_cvt_pk_bf16_f32 v99, v22, v23
  s_waitcnt lgkmcnt(2)
  v_mfma_f32_32x32x8_bf16 v[32:47], v[116:117], v[108:109], v[32:47]
  ds_read_b64 v[116:117], v65 offset:16128
  v_exp_f32 v24, v24
  v_exp_f32 v25, v25
  v_exp_f32 v26, v26
  v_exp_f32 v27, v27
  v_cvt_pk_bf16_f32 v100, v24, v25
  v_cvt_pk_bf16_f32 v101, v26, v27
  v_mfma_f32_32x32x16_bf16 v[48:63], v[120:123], v[96:99], v[48:63]
  ds_read_b128 v[120:123], v66 offset:13440
  v_exp_f32 v28, v28
  v_exp_f32 v29, v29
  v_exp_f32 v30, v30
  v_exp_f32 v31, v31
  v_cvt_pk_bf16_f32 v102, v28, v29
  v_cvt_pk_bf16_f32 v103, v30, v31
  v_exp_f32 v32, v32
  v_exp_f32 v33, v33
  s_waitcnt lgkmcnt(2)
  v_mfma_f32_32x32x16_bf16 v[48:63], v[124:127], v[100:103], v[48:63]
  ds_read_b128 v[124:127], v66 offset:14144
  v_exp_f32 v34, v34
  v_exp_f32 v35, v35
  v_cvt_pk_bf16_f32 v96, v32, v33
  v_cvt_pk_bf16_f32 v97, v34, v35
  v_mfma_f32_32x32x16_bf16 v[16:31], v[112:115], v[104:107], v[80:95]
  ds_read_b128 v[112:115], v64 offset:18816
  v_exp_f32 v36, v36
  v_exp_f32 v37, v37
  v_exp_f32 v38, v38
  v_exp_f32 v39, v39
  v_cvt_pk_bf16_f32 v98, v36, v37
  v_cvt_pk_bf16_f32 v99, v38, v39
  s_waitcnt lgkmcnt(2)
  v_mfma_f32_32x32x8_bf16 v[16:31], v[116:117], v[108:109], v[16:31]
  ds_read_b64 v[116:117], v65 offset:18816
  v_exp_f32 v40, v40
  v_exp_f32 v41, v41
  v_exp_f32 v42, v42
  v_exp_f32 v43, v43
  v_cvt_pk_bf16_f32 v100, v40, v41
  v_cvt_pk_bf16_f32 v101, v42, v43
  v_mfma_f32_32x32x16_bf16 v[48:63], v[120:123], v[96:99], v[48:63]
  ds_read_b128 v[120:123], v66 offset:16128
  v_exp_f32 v44, v44
  v_exp_f32 v45, v45
  v_exp_f32 v46, v46
  v_exp_f32 v47, v47
  v_cvt_pk_bf16_f32 v102, v44, v45
  v_cvt_pk_bf16_f32 v103, v46, v47
  s_waitcnt vmcnt(0)
  s_cmp_lg_u32 s30, 7
  s_cbranch_scc1 A_nf6
  v_cmp_ne_u32 vcc, s31, v72
  s_nop 1
  s_cmp_eq_u64 vcc, 0
  s_cbranch_scc1 A_nf6
  s_lshl_b32 s54, s61, 4
  v_lshlrev_b32 v6, 7, v1
  s_lshl_b32 s63, s54, 7
  s_mov_b32 s56, 200063
  s_mov_b64 s[100:101], exec
  s_mov_b32 exec_lo, 65535
  s_mov_b32 exec_hi, 0
A7c_poll:
  s_and_b32 s62, s56, 63
  s_cmp_eq_u32 s62, 0
  s_cbranch_scc1 A7c_poll_atom
  buffer_load_dword v7, v6, s[36:39], s63 offen sc1
  s_branch A7c_poll_got
A7c_poll_atom:
  v_mov_b32 v7, 0
  buffer_atomic_add v7, v6, s[36:39], s63 offen sc0 sc1
A7c_poll_got:
  s_waitcnt vmcnt(0)
  v_cmp_ne_u32 vcc, s31, v7
  s_nop 1
  s_and_b64 exec, exec, vcc
  s_cbranch_execz A7c_poll_done
  s_sub_u32 s56, s56, 1
  s_cmp_eq_u32 s56, 0
  s_cbranch_scc1 A7c_poll_done
  s_sleep 1
  s_branch A7c_poll
A7c_poll_done:
  s_mov_b64 exec, s[100:101]
A_nf6:
  s_barrier
  s_cmp_lt_u32 s30, 4
  s_cbranch_scc1 A_pr6
  s_setprio 1
A_pr6:
  s_cmp_ge_u32 s30, 4
  s_cbranch_scc1 A_dm_9
  s_add_u32 s54, s60, s59
  s_add_u32 s55, s58, s59
  s_add_u32 m0, s54, 0
  s_add_u32 s56, s55, 0
  buffer_load_dwordx4 v15, s[40:43], s56 offen sc1 lds
  s_add_u32 m0, s54, 4096
  s_add_u32 s56, s55, 4096
  buffer_load_dwordx4 v15, s[40:43], s56 offen sc1 lds
  s_add_u32 m0, s54, 8192
  s_add_u32 s56, s55, 8192
  buffer_load_dwordx4 v15, s[40:43], s56 offen sc1 lds
  s_add_u32 m0, s54, 12288
  s_add_u32 s56, s55, 12288
  buffer_load_dwordx4 v15, s[40:43], s56 offen sc1 lds
  s_add_u32 m0, s54, 16384
  s_add_u32 s56, s55, 16384
  buffer_load_dwordx4 v15, s[40:43], s56 offen sc1 lds
  s_cmp_lg_u32 s30, 0
  s_cbranch_scc1 A_dm_9
  s_add_u32 m0, s54, 20480
  s_add_u32 s56, s55, 20480
  buffer_load_dwordx4 v15, s[40:43], s56 offen sc1 lds
A_dm_9:
  s_add_u32 s58, s58, 21504
  s_cmp_eq_u32 s58, 172032
  s_cselect_b32 s58, 0, s58
  s_add_u32 s61, s61, 1
  s_and_b32 s61, s61, 7
  s_add_u32 s60, s60, 21504
  s_cmp_eq_u32 s60, 64512
  s_cselect_b32 s60, 0, s60
  v_exp_f32 v16, v16
  v_exp_f32 v17, v17
  s_waitcnt lgkmcnt(2)
  v_mfma_f32_32x32x16_bf16 v[48:63], v[124:127], v[100:103], v[48:63]
  ds_read_b128 v[124:127], v66 offset:16832
  v_exp_f32 v18, v18
  v_exp_f32 v19, v19
  v_cvt_pk_bf16_f32 v96, v16, v17
  v_cvt_pk_bf16_f32 v97, v18, v19
  v_mfma_f32_32x32x16_bf16 v[32:47], v[112:115], v[104:107], v[80:95]
  ds_read_b128 v[112:115], v67 offset:0
  v_exp_f32 v20, v20
  v_exp_f32 v21, v21
  v_exp_f32 v22, v22
  v_exp_f32 v23, v23
  v_cvt_pk_bf16_f32 v98, v20, v21
  v_cvt_pk_bf16_f32 v99, v22, v23
  s_waitcnt lgkmcnt(2)
  v_mfma_f32_32x32x8_bf16 v[32:47], v[116:117], v[108:109], v[32:47]
  ds_read_b64 v[116:117], v68 offset:0
  v_exp_f32 v24, v24
  v_exp_f32 v25, v25
  v_exp_f32 v26, v26
  v_exp_f32 v27, v27
  v_cvt_pk_bf16_f32 v100, v24, v25
  v_cvt_pk_bf16_f32 v101, v26, v27
  v_mfma_f32_32x32x16_bf16 v[48:63], v[120:123], v[96:99], v[48:63]
  ds_read_b128 v[120:123], v66 offset:18816
  v_exp_f32 v28, v28
  v_exp_f32 v29, v29
  v_exp_f32 v30, v30
  v_exp_f32 v31, v31
  v_cvt_pk_bf16_f32 v102, v28, v29
  v_cvt_pk_bf16_f32 v103, v30, v31
  v_exp_f32 v32, v32
  v_exp_f32 v33, v33
  s_waitcnt lgkmcnt(2)
  v_mfma_f32_32x32x16_bf16 v[48:63], v[124:127], v[100:103], v[48:63]
  ds_read_b128 v[124:127], v66 offset:19520
  v_exp_f32 v34, v34
  v_exp_f32 v35, v35
  v_cvt_pk_bf16_f32 v96, v32, v33
  v_cvt_pk_bf16_f32 v97, v34, v35
  v_mfma_f32_32x32x16_bf16 v[16:31], v[112:115], v[104:107], v[80:95]
  ds_read_b128 v[112:115], v67 offset:2688
  v_exp_f32 v36, v36
  v_exp_f32 v37, v37
  v_exp_f32 v38, v38
  v_exp_f32 v39, v39
  v_cvt_pk_bf16_f32 v98, v36, v37
  v_cvt_pk_bf16_f32 v99, v38, v39
  s_waitcnt lgkmcnt(2)
  v_mfma_f32_32x32x8_bf16 v[16:31], v[116:117], v[108:109], v[16:31]
  ds_read_b64 v[116:117], v68 offset:2688
  v_exp_f32 v40, v40
  v_exp_f32 v41, v41
  v_exp_f32 v42, v42
  v_exp_f32 v43, v43
  v_cvt_pk_bf16_f32 v100, v40, v41
  v_cvt_pk_bf16_f32 v101, v42, v43
  v_mfma_f32_32x32x16_bf16 v[48:63], v[120:123], v[96:99], v[48:63]
  ds_read_b128 v[120:123], v69 offset:0
  v_exp_f32 v44, v44
  v_exp_f32 v45, v45
  v_exp_f32 v46, v46
  v_exp_f32 v47, v47
  v_cvt_pk_bf16_f32 v102, v44, v45
  v_cvt_pk_bf16_f32 v103, v46, v47
  v_mov_b32 v64, v67
  v_mov_b32 v65, v68
  v_mov_b32 v66, v69
  s_add_u32 s54, s60, 43008
  s_cmp_ge_u32 s54, 64512
  s_cselect_b32 s55, 64512, 0
  s_sub_u32 s54, s54, s55
  v_add_u32 v67, s54, v15
  v_add_u32 v68, s54, v70
  v_add_u32 v69, s54, v71
  s_add_u32 s57, s57, 1
  s_cmp_lt_u32 s57, 8
  s_cbranch_scc1 A_loop
  s_waitcnt lgkmcnt(0)
  v_mfma_f32_32x32x16_bf16 v[48:63], v[124:127], v[100:103], v[48:63]
  s_setprio 0
  s_nop 15
  s_mov_b32 s57, 0
A_fin:
  v_mov_b32 v4, v56
  v_mov_b32 v5, v56
  s_nop 1
  v_permlane32_swap_b32 v4, v5
  v_max3_f32 v6, |v48|, |v49|, |v50|
  v_max3_f32 v6, |v51|, |v52|, v6
  v_max3_f32 v6, |v53|, |v54|, v6
  v_max3_f32 v6, |v55|, |v56|, v6
  v_max3_f32 v6, |v57|, |v58|, v6
  v_max3_f32 v6, |v59|, |v59|, v6
  v_mov_b32 v7, 2071986176
  v_cmp_nlt_f32 vcc, v6, v7
  v_cmp_nlt_f32 s[62:63], 0, v5
  s_nop 0
  s_or_b64 vcc, vcc, s[62:63]
  s_cmp_eq_u64 vcc, 0
  s_cbranch_scc1 A_store
  s_cmp_lg_u32 s57, 0
  s_cbranch_scc1 A_store
  s_branch A_slow
A_store:
  v_rcp_f32 v6, v5
  s_nop 0
  v_mul_f32 v48, v48, v6
  v_mul_f32 v49, v49, v6
  v_mul_f32 v50, v50, v6
  v_mul_f32 v51, v51, v6
  v_mul_f32 v52, v52, v6
  v_mul_f32 v53, v53, v6
  v_mul_f32 v54, v54, v6
  v_mul_f32 v55, v55, v6
  v_mul_f32 v56, v56, v6
  v_mul_f32 v57, v57, v6
  v_mul_f32 v58, v58, v6
  v_mul_f32 v59, v59, v6
  v_cvt_pk_bf16_f32 v96, v48, v49
  v_cvt_pk_bf16_f32 v97, v50, v51
  v_cvt_pk_bf16_f32 v98, v52, v53
  v_cvt_pk_bf16_f32 v99, v54, v55
  v_cvt_pk_bf16_f32 v100, v56, v57
  v_cvt_pk_bf16_f32 v101, v58, v59
  s_mul_i32 s54, s30, 20
  v_lshlrev_b32 v7, 2, v2
  v_add_u32 v7, s54, v7
  v_lshrrev_b32 v8, 4, v7
  v_lshlrev_b32 v8, 10, v8
  v_bfe_u32 v11, v7, 3, 1
  v_lshl_add_u32 v8, v11, 9, v8
  v_and_b32 v11, 7, v7
  v_lshl_add_u32 v8, v11, 1, v8
  v_lshl_add_u32 v8, v3, 4, v8
  v_add_u32 v8, 65536, v8
  ds_write_b64 v8, v[96:97]
  v_add_u32 v7, 8, v7
  v_lshrrev_b32 v9, 4, v7
  v_lshlrev_b32 v9, 10, v9
  v_bfe_u32 v11, v7, 3, 1
  v_lshl_add_u32 v9, v11, 9, v9
  v_and_b32 v11, 7, v7
  v_lshl_add_u32 v9, v11, 1, v9
  v_lshl_add_u32 v9, v3, 4, v9
  v_add_u32 v9, 65536, v9
  ds_write_b64 v9, v[98:99]
  s_add_u32 s54, s54, 16
  v_mov_b32 v7, s54
  v_lshrrev_b32 v10, 4, v7
  v_lshlrev_b32 v10, 10, v10
  v_bfe_u32 v11, v7, 3, 1
  v_lshl_add_u32 v10, v11, 9, v10
  v_and_b32 v11, 7, v7
  v_lshl_add_u32 v10, v11, 1, v10
  v_lshl_add_u32 v10, v3, 4, v10
  v_add_u32 v10, 65536, v10
  s_mov_b32 exec_hi, 0
  ds_write_b64 v10, v[100:101]
  s_mov_b32 exec_hi, -1
  s_waitcnt lgkmcnt(0)
  s_barrier
  s_lshl_b32 s54, s30, 10
  v_add_u32 v8, s54, v15
  v_add_u32 v8, 65536, v8
  ds_read_b128 v[112:115], v8
  ds_read_b128 v[120:123], v8 offset:8192
  s_mul_i32 s55, s52, 40
  s_mul_i32 s56, s53, 10
  s_add_u32 s55, s55, s56
  s_add_u32 s55, s55, s30
  s_lshl_b32 s55, s55, 10
  s_add_u32 s55, s55, 2949120
  s_waitcnt lgkmcnt(0)
  buffer_store_dwordx4 v[112:115], v15, s[32:35], s55 offen sc1
  s_cmp_ge_u32 s30, 2
  s_cbranch_scc1 A_o1
  s_add_u32 s55, s55, 8192
  buffer_store_dwordx4 v[120:123], v15, s[32:35], s55 offen sc1
A_o1:
  v_mov_b32 v4, 81904
  ds_read_b32 v5, v4
  s_waitcnt vmcnt(0) lgkmcnt(0)
  v_readfirstlane_b32 s31, v5
  s_lshl_b32 s54, s52, 2
  s_add_u32 s54, s54, s53
  s_lshl_b32 s54, s54, 3
  s_add_u32 s54, s54, s30
  v_mov_b32 v4, s31
  v_mov_b32 v5, 0
  s_lshl_b32 s63, s54, 7
  s_add_u32 s63, s63, 147456
  s_mov_b64 s[100:101], exec
  s_mov_b64 exec, 1
  buffer_store_dword v4, v5, s[36:39], s63 offen sc1
  s_mov_b64 exec, s[100:101]
  s_endpgm
A_slow:
  v_mov_b32 v110, 0xff800000
  s_mov_b32 s58, 0
A_slow1:
  buffer_load_dwordx4 v[112:115], v15, s[40:43], s58 offen sc1
  buffer_load_dwordx2 v[116:117], v70, s[40:43], s58 offen sc1
  s_waitcnt vmcnt(0)
  v_mfma_f32_32x32x16_bf16 v[16:31], v[112:115], v[104:107], 0
  v_mfma_f32_32x32x8_bf16 v[16:31], v[116:117], v[108:109], v[16:31]
  s_nop 15
  v_max3_f32 v110, v16, v17, v110
  v_max3_f32 v110, v18, v19, v110
  v_max3_f32 v110, v20, v21, v110
  v_max3_f32 v110, v22, v23, v110
  v_max3_f32 v110, v24, v25, v110
  v_max3_f32 v110, v26, v27, v110
  v_max3_f32 v110, v28, v29, v110
  v_max3_f32 v110, v30, v31, v110
  s_add_u32 s58, s58, 2688
  s_cmp_lt_u32 s58, 172032
  s_cbranch_scc1 A_slow1
  v_mov_b32 v4, v110
  s_nop 1
  v_permlane32_swap_b32 v110, v4
  s_nop 0
  v_max_f32 v110, v110, v4
  v_sub_f32 v80, 0, v110
  v_sub_f32 v81, 0, v110
  v_sub_f32 v82, 0, v110
  v_sub_f32 v83, 0, v110
  v_sub_f32 v84, 0, v110
  v_sub_f32 v85, 0, v110
  v_sub_f32 v86, 0, v110
  v_sub_f32 v87, 0, v110
  v_sub_f32 v88, 0, v110
  v_sub_f32 v89, 0, v110
  v_sub_f32 v90, 0, v110
  v_sub_f32 v91, 0, v110
  v_sub_f32 v92, 0, v110
  v_sub_f32 v93, 0, v110
  v_sub_f32 v94, 0, v110
  v_sub_f32 v95, 0, v110
  v_mov_b32 v48, 0
  v_mov_b32 v49, 0
  v_mov_b32 v50, 0
  v_mov_b32 v51, 0
  v_mov_b32 v52, 0
  v_mov_b32 v53, 0
  v_mov_b32 v54, 0
  v_mov_b32 v55, 0
  v_mov_b32 v56, 0
  v_mov_b32 v57, 0
  v_mov_b32 v58, 0
  v_mov_b32 v59, 0
  v_mov_b32 v60, 0
  v_mov_b32 v61, 0
  v_mov_b32 v62, 0
  v_mov_b32 v63, 0
  s_mov_b32 s58, 0
A_slow2:
  buffer_load_dwordx4 v[112:115], v15, s[40:43], s58 offen sc1
  buffer_load_dwordx2 v[116:117], v70, s[40:43], s58 offen sc1
  buffer_load_dwordx4 v[120:123], v71, s[40:43], s58 offen sc1
  buffer_load_dwordx4 v[124:127], v71, s[40:43], s58 offen offset:704 sc1
  s_waitcnt vmcnt(0)
  v_mfma_f32_32x32x16_bf16 v[16:31], v[112:115], v[104:107], v[80:95]
  v_mfma_f32_32x32x8_bf16 v[16:31], v[116:117], v[108:109], v[16:31]
  s_nop 15
  v_exp_f32 v16, v16
  v_exp_f32 v17, v17
  v_exp_f32 v18, v18
  v_exp_f32 v19, v19
  v_exp_f32 v20, v20
  v_exp_f32 v21, v21
  v_exp_f32 v22, v22
  v_exp_f32 v23, v23
  v_exp_f32 v24, v24
  v_exp_f32 v25, v25
  v_exp_f32 v26, v26
  v_exp_f32 v27, v27
  v_exp_f32 v28, v28
  v_exp_f32 v29, v29
  v_exp_f32 v30, v30
  v_exp_f32 v31, v31
  s_nop 0
  v_cvt_pk_bf16_f32 v96, v16, v17
  v_cvt_pk_bf16_f32 v97, v18, v19
  v_cvt_pk_bf16_f32 v98, v20, v21
  v_cvt_pk_bf16_f32 v99, v22, v23
  v_cvt_pk_bf16_f32 v100, v24, v25
  v_cvt_pk_bf16_f32 v101, v26, v27
  v_cvt_pk_bf16_f32 v102, v28, v29
  v_cvt_pk_bf16_f32 v103, v30, v31
  s_nop 1
  v_mfma_f32_32x32x16_bf16 v[48:63], v[120:123], v[96:99], v[48:63]
  v_mfma_f32_32x32x16_bf16 v[48:63], v[124:127], v[100:103], v[48:63]
  s_add_u32 s58, s58, 2688
  s_cmp_lt_u32 s58, 172032
  s_cbranch_scc1 A_slow2
  s_nop 15
  s_mov_b32 s57, 1
  s_branch A_fin
ROLE_B:
  s_waitcnt lgkmcnt(0)
  s_mov_b32 s32, s28
  s_mov_b32 s33, s29
  s_mov_b32 s34, 15138816
  s_mov_b32 s35, 0x00020000
  s_add_u32 s36, s28, 11862016
  s_addc_u32 s37, s29, 0
  s_mov_b32 s38, 409600
  s_mov_b32 s39, 0x00020000
  s_mov_b32 s40, s28
  s_mov_b32 s41, s29
  s_mov_b32 s42, 15138816
  s_mov_b32 s43, 0x00020000
  s_mov_b32 s44, s28
  s_mov_b32 s45, s29
  s_mov_b32 s46, 15138816
  s_mov_b32 s47, 0x00020000
  s_mov_b32 s48, s28
  s_mov_b32 s49, s29
  s_mov_b32 s50, 15138816
  s_mov_b32 s51, 0x00020000
  v_mov_b32 v6, 0
  v_mov_b32 v7, 0
  v_mov_b32 v8, 0
  v_mov_b32 v9, 0
  v_mov_b32 v10, 0
  v_mov_b32 v11, 0
  v_mov_b32 v12, 0
  v_mov_b32 v13, 0
  v_mov_b32 v14, 0
  v_mov_b32 v15, 0
  v_mov_b32 v4, 0
  v_mov_b32 v5, 0
  s_sub_u32 s55, s2, 256
  s_bfe_u32 s52, s55, 0x20001
  s_lshl_b32 s52, s52, 2
  s_bfe_u32 s54, s55, 0x20003
  s_add_u32 s52, s52, s54
  s_and_b32 s53, s55, 1
  s_lshl_b32 s53, s53, 3
  s_lshr_b32 s54, s55, 5
  s_add_u32 s53, s53, s54
  s_lshr_b32 s60, s30, 2
  v_lshlrev_b32 v14, 4, v1
  s_and_b32 s54, s30, 3
  s_mul_i32 s54, s54, 192
  s_mul_i32 s55, s53, 192
  s_mul_i32 s56, s60, 983040
  s_add_u32 s55, s55, s56
  v_add_u32 v4, s54, v1
  v_mul_u32_u24 v5, 5462, v4
  v_lshrrev_b32 v5, 16, v5
  v_mul_u32_u24 v6, 12, v5
  v_sub_u32 v4, v4, v6
  v_lshlrev_b32 v4, 4, v4
  v_mul_u32_u24 v5, 3072, v5
  v_add3_u32 v10, v4, v5, s55
  v_add_u32 v4, s54, v1
  v_add_u32 v4, 64, v4
  v_mul_u32_u24 v5, 5462, v4
  v_lshrrev_b32 v5, 16, v5
  v_mul_u32_u24 v6, 12, v5
  v_sub_u32 v4, v4, v6
  v_lshlrev_b32 v4, 4, v4
  v_mul_u32_u24 v5, 3072, v5
  v_add3_u32 v11, v4, v5, s55
  v_subrev_u32 v11, 1024, v11
  v_add_u32 v4, s54, v1
  v_add_u32 v4, 128, v4
  v_mul_u32_u24 v5, 5462, v4
  v_lshrrev_b32 v5, 16, v5
  v_mul_u32_u24 v6, 12, v5
  v_sub_u32 v4, v4, v6
  v_lshlrev_b32 v4, 4, v4
  v_mul_u32_u24 v5, 3072, v5
  v_add3_u32 v12, v4, v5, s55
  v_subrev_u32 v12, 2048, v12
  s_mul_i32 s54, s60, 12288
  v_bfe_u32 v4, v1, 2, 2
  v_mul_u32_u24 v5, 8, v2
  v_add_u32 v4, v4, v5
  v_bfe_u32 v5, v1, 4, 1
  v_and_b32 v6, 3, v1
  v_lshlrev_b32 v6, 3, v6
  v_lshl_add_u32 v5, v5, 5, v6
  v_mul_u32_u24 v13, 192, v4
  v_add3_u32 v13, v13, v5, s54
  s_mul_i32 s59, s30, 3072
  s_mov_b32 s40, s16
  s_mov_b32 s41, s17
  s_mov_b32 s42, 1966080
  s_mov_b32 s43, 0x00020000
  s_mov_b32 s44, s18
  s_mov_b32 s45, s19
  s_mov_b32 s46, 3072
  s_mov_b32 s47, 0x00020000
  s_mul_hi_u32 s54, s53, 858993460
  s_mul_i32 s54, s54, 5
  s_sub_u32 s54, s53, s54
  s_mul_i32 s57, s54, 196608
  s_lshl_b32 s58, s54, 12
  s_and_b32 s54, s30, 3
  s_lshl_b32 s55, s52, 2
  s_add_u32 s54, s54, s55
  s_mul_i32 s99, s54, 40960
  s_mul_i32 s55, s60, 20480
  s_add_u32 s99, s99, s55
  s_sub_u32 s96, s2, 256
  s_cmp_lg_u32 s30, 0
  s_cbranch_scc1 B1_np
  s_mov_b32 s56, 200063
  v_mov_b32 v4, 0
B1_tag:
  global_load_dword v5, v4, s[26:27] sc1
  s_waitcnt vmcnt(0)
  v_readfirstlane_b32 s31, v5
  s_sub_u32 s56, s56, 1
  s_cmp_eq_u32 s56, 0
  s_cbranch_scc1 B1_tag_done
  s_cmp_eq_u32 s31, 0
  s_cbranch_scc0 B1_tag_val
  s_and_b32 s62, s56, 31
  s_cmp_eq_u32 s62, 0
  s_cbranch_scc1 B1_tag_atom
  s_sleep 1
  s_branch B1_tag
B1_tag_val:
  s_memrealtime s[62:63]
  s_waitcnt lgkmcnt(0)
  s_sub_u32 s62, s62, s31
  s_cmp_lt_u32 s62, 2000
  s_cbranch_scc1 B1_tag_done
B1_tag_atom:
  s_mov_b64 s[62:63], exec
  s_mov_b64 exec, 1
  v_mov_b32 v5, 0
  global_atomic_add v5, v4, v5, s[26:27] sc0 sc1
  s_mov_b64 exec, s[62:63]
  s_waitcnt vmcnt(0)
  v_readfirstlane_b32 s31, v5
  s_cmp_eq_u32 s31, 0
  s_cbranch_scc0 B1_tag_done
  s_sub_u32 s56, s56, 1
  s_cmp_eq_u32 s56, 0
  s_cbranch_scc1 B1_tag_done
  s_sleep 1
  s_branch B1_tag
B1_tag_done:
  s_lshl_b32 s54, s52, 5
  v_lshlrev_b32 v4, 7, v1
  s_lshl_b32 s63, s54, 7
  s_add_u32 s63, s63, 16384
  s_mov_b32 s56, 1
  s_mov_b64 s[100:101], exec
  s_mov_b32 exec_lo, -1
  s_mov_b32 exec_hi, 0
B1p_poll:
  s_and_b32 s62, s56, 63
  s_cmp_eq_u32 s62, 0
  s_cbranch_scc1 B1p_poll_atom
  buffer_load_dword v5, v4, s[36:39], s63 offen sc1
  s_branch B1p_poll_got
B1p_poll_atom:
  v_mov_b32 v5, 0
  buffer_atomic_add v5, v4, s[36:39], s63 offen sc0 sc1
B1p_poll_got:
  s_waitcnt vmcnt(0)
  v_cmp_ne_u32 vcc, s31, v5
  s_nop 1
  s_and_b64 exec, exec, vcc
  s_cbranch_execz B1p_poll_done
  s_sub_u32 s56, s56, 1
  s_cmp_eq_u32 s56, 0
  s_cbranch_scc1 B1p_poll_done
  s_sleep 8
  s_branch B1p_poll
B1p_poll_done:
  s_mov_b64 exec, s[100:101]
B1_np:
  s_barrier
  s_mov_b32 s48, s20
  s_mov_b32 s49, s21
  s_mov_b32 s50, 1966080
  s_mov_b32 s51, 0x00020000
  v_lshrrev_b32 v92, 2, v1
  v_mul_u32_u24 v92, 1280, v92
  v_and_b32 v93, 3, v1
  v_lshl_add_u32 v92, v93, 4, v92
  s_lshl_b32 s54, s30, 10
  s_add_u32 s54, s54, 73728
  v_add_u32 v93, s54, v14
  v_bfe_u32 v4, v1, 2, 2
  v_mul_u32_u24 v5, 4, v2
  v_add_u32 v4, v4, v5
  v_bfe_u32 v5, v1, 4, 1
  v_and_b32 v6, 3, v1
  v_lshlrev_b32 v6, 3, v6
  v_lshl_add_u32 v5, v5, 5, v6
  v_mul_u32_u24 v94, 64, v4
  v_add3_u32 v94, v94, v5, s54
  v_bfe_u32 v4, v1, 2, 2
  v_mul_u32_u24 v5, 8, v2
  v_add_u32 v4, v4, v5
  v_bfe_u32 v5, v1, 4, 1
  v_and_b32 v6, 3, v1
  v_lshlrev_b32 v6, 3, v6
  v_lshl_add_u32 v5, v5, 5, v6
  v_mul_u32_u24 v95, 64, v4
  v_add3_u32 v95, v95, v5, s54
  s_mov_b32 s94, -1
  s_and_b32 s54, s96, 63
  s_mul_i32 s54, s54, 11
  s_add_u32 s54, s54, s30
  s_cmp_ge_u32 s54, 680
  s_cbranch_scc1 B1_wf0_skip
  s_mul_hi_u32 s55, s54, 31580642
  s_mul_i32 s56, s55, 136
  s_sub_u32 s54, s54, s56
  s_mov_b32 s94, s54
  s_lshr_b32 s56, s96, 6
  s_mul_i32 s56, s56, 5
  s_add_u32 s55, s55, s56
  s_mul_i32 s62, s55, 136
  s_add_u32 s62, s62, s54
  s_lshl_b32 s62, s62, 10
  s_add_u32 s92, s62, 12320768
  s_lshl_b32 s55, s55, 6
  s_cmp_lt_u32 s54, 96
  s_cselect_b32 s48, s20, s12
  s_cselect_b32 s49, s21, s13
  s_cselect_b32 s63, 0, 96
  s_mov_b32 s50, 819200
  s_cbranch_scc0 B1_wf0_a
  s_mov_b32 s50, 1966080
B1_wf0_a:
  s_sub_u32 s56, s54, s63
  s_mul_i32 s56, s56, 20480
  s_add_u32 s56, s56, s55
  buffer_load_dwordx4 v[76:79], v92, s[48:51], s56 offen
B1_wf0_skip:
  s_mov_b32 s95, -1
  s_cmp_ge_u32 s30, 3
  s_cbranch_scc1 B1_wf1_skip
  s_and_b32 s54, s96, 63
  s_mul_i32 s54, s54, 11
  s_add_u32 s54, s54, s30
  s_add_u32 s54, s54, 8
  s_cmp_ge_u32 s54, 680
  s_cbranch_scc1 B1_wf1_skip
  s_mul_hi_u32 s55, s54, 31580642
  s_mul_i32 s56, s55, 136
  s_sub_u32 s54, s54, s56
  s_mov_b32 s95, s54
  s_lshr_b32 s56, s96, 6
  s_mul_i32 s56, s56, 5
  s_add_u32 s55, s55, s56
  s_mul_i32 s62, s55, 136
  s_add_u32 s62, s62, s54
  s_lshl_b32 s62, s62, 10
  s_add_u32 s93, s62, 12320768
  s_lshl_b32 s55, s55, 6
  s_cmp_lt_u32 s54, 96
  s_cselect_b32 s48, s20, s12
  s_cselect_b32 s49, s21, s13
  s_cselect_b32 s63, 0, 96
  s_mov_b32 s50, 819200
  s_cbranch_scc0 B1_wf1_a
  s_mov_b32 s50, 1966080
B1_wf1_a:
  s_sub_u32 s56, s54, s63
  s_mul_i32 s56, s56, 20480
  s_add_u32 s56, s56, s55
  buffer_load_dwordx4 v[80:83], v92, s[48:51], s56 offen
B1_wf1_skip:
  s_waitcnt vmcnt(0)
  s_cmp_eq_u32 s94, -1
  s_cbranch_scc1 B1_wg0_skip
  ds_write_b128 v93, v[76:79]
  s_cmp_lt_u32 s94, 96
  s_cbranch_scc0 B1_wf0_n
  ds_read_b64_tr_b16 v[84:85], v94
  ds_read_b64_tr_b16 v[86:87], v94 offset:512
  s_branch B1_wf0_s
B1_wf0_n:
  ds_read_b64_tr_b16 v[84:85], v95
  ds_read_b64_tr_b16 v[86:87], v95 offset:256
B1_wf0_s:
  s_waitcnt lgkmcnt(0)
  buffer_store_dwordx4 v[84:87], v14, s[32:35], s92 offen sc1
B1_wg0_skip:
  s_cmp_eq_u32 s95, -1
  s_cbranch_scc1 B1_wg1_skip
  ds_write_b128 v93, v[80:83]
  s_cmp_lt_u32 s95, 96
  s_cbranch_scc0 B1_wf1_n
  ds_read_b64_tr_b16 v[88:89], v94
  ds_read_b64_tr_b16 v[90:91], v94 offset:512
  s_branch B1_wf1_s
B1_wf1_n:
  ds_read_b64_tr_b16 v[88:89], v95
  ds_read_b64_tr_b16 v[90:91], v95 offset:256
B1_wf1_s:
  s_waitcnt lgkmcnt(0)
  buffer_store_dwordx4 v[88:91], v14, s[32:35], s93 offen sc1
B1_wg1_skip:
  s_cmp_lg_u32 s30, 0
  s_cbranch_scc1 B1_np2
  s_lshl_b32 s54, s52, 5
  v_lshlrev_b32 v4, 7, v1
  s_lshl_b32 s63, s54, 7
  s_add_u32 s63, s63, 16384
  s_mov_b32 s56, 200063
  s_mov_b64 s[100:101], exec
  s_mov_b32 exec_lo, -1
  s_mov_b32 exec_hi, 0
B1_poll:
  s_and_b32 s62, s56, 63
  s_cmp_eq_u32 s62, 0
  s_cbranch_scc1 B1_poll_atom
  buffer_load_dword v5, v4, s[36:39], s63 offen sc1
  s_branch B1_poll_got
B1_poll_atom:
  v_mov_b32 v5, 0
  buffer_atomic_add v5, v4, s[36:39], s63 offen sc0 sc1
B1_poll_got:
  s_waitcnt vmcnt(0)
  v_cmp_ne_u32 vcc, s31, v5
  s_nop 1
  s_and_b64 exec, exec, vcc
  s_cbranch_execz B1_poll_done
  s_sub_u32 s56, s56, 1
  s_cmp_eq_u32 s56, 0
  s_cbranch_scc1 B1_poll_done
  s_sleep 8
  s_branch B1_poll
B1_poll_done:
  s_mov_b64 exec, s[100:101]
B1_np2:
  s_barrier
  s_cmp_lg_u32 s30, 0
  s_cbranch_scc1 B1_ntl
  v_mov_b32 v4, 81904
  v_mov_b32 v5, s31
  ds_write_b32 v4, v5
B1_ntl:
  s_add_u32 m0, s59, 0
  s_add_u32 s54, s57, 196608
  buffer_load_dwordx4 v10, s[40:43], s57 offen offset:0 lds
  buffer_load_dwordx4 v11, s[40:43], s57 offen offset:1024 lds
  buffer_load_dwordx4 v12, s[40:43], s57 offen offset:2048 lds
  s_cmp_eq_u32 s54, 983040
  s_cselect_b32 s57, 0, s54
  s_add_u32 s55, s99, s58
  s_add_u32 s54, s58, 4096
  buffer_load_dwordx4 v[16:19], v14, s[32:35], s55 offen offset:0 sc1
  buffer_load_dwordx4 v[20:23], v14, s[32:35], s55 offen offset:1024 sc1
  buffer_load_dwordx4 v[24:27], v14, s[32:35], s55 offen offset:2048 sc1
  buffer_load_dwordx4 v[28:31], v14, s[32:35], s55 offen offset:3072 sc1
  s_cmp_eq_u32 s54, 20480
  s_cselect_b32 s58, 0, s54
  s_waitcnt vmcnt(0)
  s_barrier
  s_cmp_lg_u32 s30, 0
  s_cbranch_scc1 B1_nofw
  v_mov_b32 v4, s31
  v_mov_b32 v5, 0
  s_lshl_b32 s63, s96, 7
  s_add_u32 s63, s63, 114688
  s_mov_b64 s[100:101], exec
  s_mov_b64 exec, 1
  buffer_store_dword v4, v5, s[36:39], s63 offen sc1
  s_mov_b64 exec, s[100:101]
B1_nofw:
  s_add_u32 m0, s59, 24576
  s_add_u32 s54, s57, 196608
  buffer_load_dwordx4 v10, s[40:43], s57 offen offset:0 lds
  buffer_load_dwordx4 v11, s[40:43], s57 offen offset:1024 lds
  buffer_load_dwordx4 v12, s[40:43], s57 offen offset:2048 lds
  s_cmp_eq_u32 s54, 983040
  s_cselect_b32 s57, 0, s54
  s_add_u32 s55, s99, s58
  s_add_u32 s54, s58, 4096
  buffer_load_dwordx4 v[32:35], v14, s[32:35], s55 offen offset:0 sc1
  buffer_load_dwordx4 v[36:39], v14, s[32:35], s55 offen offset:1024 sc1
  buffer_load_dwordx4 v[40:43], v14, s[32:35], s55 offen offset:2048 sc1
  buffer_load_dwordx4 v[44:47], v14, s[32:35], s55 offen offset:3072 sc1
  s_cmp_eq_u32 s54, 20480
  s_cselect_b32 s58, 0, s54
  ds_read_b64_tr_b16 v[48:49], v13 offset:0
  ds_read_b64_tr_b16 v[50:51], v13 offset:768
  ds_read_b64_tr_b16 v[52:53], v13 offset:64
  ds_read_b64_tr_b16 v[54:55], v13 offset:832
  ds_read_b64_tr_b16 v[56:57], v13 offset:128
  ds_read_b64_tr_b16 v[58:59], v13 offset:896
  ds_read_b64_tr_b16 v[60:61], v13 offset:3072
  ds_read_b64_tr_b16 v[62:63], v13 offset:3840
  ds_read_b64_tr_b16 v[64:65], v13 offset:3136
  ds_read_b64_tr_b16 v[66:67], v13 offset:3904
  ds_read_b64_tr_b16 v[68:69], v13 offset:3200
  ds_read_b64_tr_b16 v[70:71], v13 offset:3968
  s_waitcnt lgkmcnt(6)
  v_mfma_f32_32x32x16_bf16 v[76:91], v[48:51], v[16:19], 0
  v_mfma_f32_32x32x16_bf16 v[92:107], v[52:55], v[16:19], 0
  v_mfma_f32_32x32x16_bf16 v[108:123], v[56:59], v[16:19], 0
  ds_read_b64_tr_b16 v[48:49], v13 offset:6144
  ds_read_b64_tr_b16 v[50:51], v13 offset:6912
  ds_read_b64_tr_b16 v[52:53], v13 offset:6208
  ds_read_b64_tr_b16 v[54:55], v13 offset:6976
  ds_read_b64_tr_b16 v[56:57], v13 offset:6272
  ds_read_b64_tr_b16 v[58:59], v13 offset:7040
  s_waitcnt lgkmcnt(6)
  v_mfma_f32_32x32x16_bf16 v[76:91], v[60:63], v[20:23], v[76:91]
  v_mfma_f32_32x32x16_bf16 v[92:107], v[64:67], v[20:23], v[92:107]
  v_mfma_f32_32x32x16_bf16 v[108:123], v[68:71], v[20:23], v[108:123]
  ds_read_b64_tr_b16 v[60:61], v13 offset:9216
  ds_read_b64_tr_b16 v[62:63], v13 offset:9984
  ds_read_b64_tr_b16 v[64:65], v13 offset:9280
  ds_read_b64_tr_b16 v[66:67], v13 offset:10048
  ds_read_b64_tr_b16 v[68:69], v13 offset:9344
  ds_read_b64_tr_b16 v[70:71], v13 offset:10112
  s_waitcnt lgkmcnt(6)
  v_mfma_f32_32x32x16_bf16 v[76:91], v[48:51], v[24:27], v[76:91]
  v_mfma_f32_32x32x16_bf16 v[92:107], v[52:55], v[24:27], v[92:107]
  v_mfma_f32_32x32x16_bf16 v[108:123], v[56:59], v[24:27], v[108:123]
  s_waitcnt lgkmcnt(0)
  v_mfma_f32_32x32x16_bf16 v[76:91], v[60:63], v[28:31], v[76:91]
  v_mfma_f32_32x32x16_bf16 v[92:107], v[64:67], v[28:31], v[92:107]
  v_mfma_f32_32x32x16_bf16 v[108:123], v[68:71], v[28:31], v[108:123]
  s_waitcnt vmcnt(0)
  s_barrier
  s_add_u32 m0, s59, 49152
  s_add_u32 s54, s57, 196608
  buffer_load_dwordx4 v10, s[40:43], s57 offen offset:0 lds
  buffer_load_dwordx4 v11, s[40:43], s57 offen offset:1024 lds
  buffer_load_dwordx4 v12, s[40:43], s57 offen offset:2048 lds
  s_cmp_eq_u32 s54, 983040
  s_cselect_b32 s57, 0, s54
  s_add_u32 s55, s99, s58
  s_add_u32 s54, s58, 4096
  buffer_load_dwordx4 v[16:19], v14, s[32:35], s55 offen offset:0 sc1
  buffer_load_dwordx4 v[20:23], v14, s[32:35], s55 offen offset:1024 sc1
  buffer_load_dwordx4 v[24:27], v14, s[32:35], s55 offen offset:2048 sc1
  buffer_load_dwordx4 v[28:31], v14, s[32:35], s55 offen offset:3072 sc1
  s_cmp_eq_u32 s54, 20480
  s_cselect_b32 s58, 0, s54
  ds_read_b64_tr_b16 v[48:49], v13 offset:24576
  ds_read_b64_tr_b16 v[50:51], v13 offset:25344
  ds_read_b64_tr_b16 v[52:53], v13 offset:24640
  ds_read_b64_tr_b16 v[54:55], v13 offset:25408
  ds_read_b64_tr_b16 v[56:57], v13 offset:24704
  ds_read_b64_tr_b16 v[58:59], v13 offset:25472
  ds_read_b64_tr_b16 v[60:61], v13 offset:27648
  ds_read_b64_tr_b16 v[62:63], v13 offset:28416
  ds_read_b64_tr_b16 v[64:65], v13 offset:27712
  ds_read_b64_tr_b16 v[66:67], v13 offset:28480
  ds_read_b64_tr_b16 v[68:69], v13 offset:27776
  ds_read_b64_tr_b16 v[70:71], v13 offset:28544
  s_waitcnt lgkmcnt(6)
  v_mfma_f32_32x32x16_bf16 v[76:91], v[48:51], v[32:35], v[76:91]
  v_mfma_f32_32x32x16_bf16 v[92:107], v[52:55], v[32:35], v[92:107]
  v_mfma_f32_32x32x16_bf16 v[108:123], v[56:59], v[32:35], v[108:123]
  ds_read_b64_tr_b16 v[48:49], v13 offset:30720
  ds_read_b64_tr_b16 v[50:51], v13 offset:31488
  ds_read_b64_tr_b16 v[52:53], v13 offset:30784
  ds_read_b64_tr_b16 v[54:55], v13 offset:31552
  ds_read_b64_tr_b16 v[56:57], v13 offset:30848
  ds_read_b64_tr_b16 v[58:59], v13 offset:31616
  s_waitcnt lgkmcnt(6)
  v_mfma_f32_32x32x16_bf16 v[76:91], v[60:63], v[36:39], v[76:91]
  v_mfma_f32_32x32x16_bf16 v[92:107], v[64:67], v[36:39], v[92:107]
  v_mfma_f32_32x32x16_bf16 v[108:123], v[68:71], v[36:39], v[108:123]
  ds_read_b64_tr_b16 v[60:61], v13 offset:33792
  ds_read_b64_tr_b16 v[62:63], v13 offset:34560
  ds_read_b64_tr_b16 v[64:65], v13 offset:33856
  ds_read_b64_tr_b16 v[66:67], v13 offset:34624
  ds_read_b64_tr_b16 v[68:69], v13 offset:33920
  ds_read_b64_tr_b16 v[70:71], v13 offset:34688
  s_waitcnt lgkmcnt(6)
  v_mfma_f32_32x32x16_bf16 v[76:91], v[48:51], v[40:43], v[76:91]
  v_mfma_f32_32x32x16_bf16 v[92:107], v[52:55], v[40:43], v[92:107]
  v_mfma_f32_32x32x16_bf16 v[108:123], v[56:59], v[40:43], v[108:123]
  s_waitcnt lgkmcnt(0)
  v_mfma_f32_32x32x16_bf16 v[76:91], v[60:63], v[44:47], v[76:91]
  v_mfma_f32_32x32x16_bf16 v[92:107], v[64:67], v[44:47], v[92:107]
  v_mfma_f32_32x32x16_bf16 v[108:123], v[68:71], v[44:47], v[108:123]
  s_waitcnt vmcnt(0)
  s_barrier
  s_add_u32 m0, s59, 0
  s_add_u32 s54, s57, 196608
  buffer_load_dwordx4 v10, s[40:43], s57 offen offset:0 lds
  buffer_load_dwordx4 v11, s[40:43], s57 offen offset:1024 lds
  buffer_load_dwordx4 v12, s[40:43], s57 offen offset:2048 lds
  s_cmp_eq_u32 s54, 983040
  s_cselect_b32 s57, 0, s54
  s_add_u32 s55, s99, s58
  s_add_u32 s54, s58, 4096
  buffer_load_dwordx4 v[32:35], v14, s[32:35], s55 offen offset:0 sc1
  buffer_load_dwordx4 v[36:39], v14, s[32:35], s55 offen offset:1024 sc1
  buffer_load_dwordx4 v[40:43], v14, s[32:35], s55 offen offset:2048 sc1
  buffer_load_dwordx4 v[44:47], v14, s[32:35], s55 offen offset:3072 sc1
  s_cmp_eq_u32 s54, 20480
  s_cselect_b32 s58, 0, s54
  ds_read_b64_tr_b16 v[48:49], v13 offset:49152
  ds_read_b64_tr_b16 v[50:51], v13 offset:49920
  ds_read_b64_tr_b16 v[52:53], v13 offset:49216
  ds_read_b64_tr_b16 v[54:55], v13 offset:49984
  ds_read_b64_tr_b16 v[56:57], v13 offset:49280
  ds_read_b64_tr_b16 v[58:59], v13 offset:50048
  ds_read_b64_tr_b16 v[60:61], v13 offset:52224
  ds_read_b64_tr_b16 v[62:63], v13 offset:52992
  ds_read_b64_tr_b16 v[64:65], v13 offset:52288
  ds_read_b64_tr_b16 v[66:67], v13 offset:53056
  ds_read_b64_tr_b16 v[68:69], v13 offset:52352
  ds_read_b64_tr_b16 v[70:71], v13 offset:53120
  s_waitcnt lgkmcnt(6)
  v_mfma_f32_32x32x16_bf16 v[76:91], v[48:51], v[16:19], v[76:91]
  v_mfma_f32_32x32x16_bf16 v[92:107], v[52:55], v[16:19], v[92:107]
  v_mfma_f32_32x32x16_bf16 v[108:123], v[56:59], v[16:19], v[108:123]
  ds_read_b64_tr_b16 v[48:49], v13 offset:55296
  ds_read_b64_tr_b16 v[50:51], v13 offset:56064
  ds_read_b64_tr_b16 v[52:53], v13 offset:55360
  ds_read_b64_tr_b16 v[54:55], v13 offset:56128
  ds_read_b64_tr_b16 v[56:57], v13 offset:55424
  ds_read_b64_tr_b16 v[58:59], v13 offset:56192
  s_waitcnt lgkmcnt(6)
  v_mfma_f32_32x32x16_bf16 v[76:91], v[60:63], v[20:23], v[76:91]
  v_mfma_f32_32x32x16_bf16 v[92:107], v[64:67], v[20:23], v[92:107]
  v_mfma_f32_32x32x16_bf16 v[108:123], v[68:71], v[20:23], v[108:123]
  ds_read_b64_tr_b16 v[60:61], v13 offset:58368
  ds_read_b64_tr_b16 v[62:63], v13 offset:59136
  ds_read_b64_tr_b16 v[64:65], v13 offset:58432
  ds_read_b64_tr_b16 v[66:67], v13 offset:59200
  ds_read_b64_tr_b16 v[68:69], v13 offset:58496
  ds_read_b64_tr_b16 v[70:71], v13 offset:59264
  s_waitcnt lgkmcnt(6)
  v_mfma_f32_32x32x16_bf16 v[76:91], v[48:51], v[24:27], v[76:91]
  v_mfma_f32_32x32x16_bf16 v[92:107], v[52:55], v[24:27], v[92:107]
  v_mfma_f32_32x32x16_bf16 v[108:123], v[56:59], v[24:27], v[108:123]
  s_waitcnt lgkmcnt(0)
  v_mfma_f32_32x32x16_bf16 v[76:91], v[60:63], v[28:31], v[76:91]
  v_mfma_f32_32x32x16_bf16 v[92:107], v[64:67], v[28:31], v[92:107]
  v_mfma_f32_32x32x16_bf16 v[108:123], v[68:71], v[28:31], v[108:123]
  s_waitcnt vmcnt(0)
  s_barrier
  s_add_u32 m0, s59, 24576
  s_add_u32 s54, s57, 196608
  buffer_load_dwordx4 v10, s[40:43], s57 offen offset:0 lds
  buffer_load_dwordx4 v11, s[40:43], s57 offen offset:1024 lds
  buffer_load_dwordx4 v12, s[40:43], s57 offen offset:2048 lds
  s_cmp_eq_u32 s54, 983040
  s_cselect_b32 s57, 0, s54
  s_add_u32 s55, s99, s58
  s_add_u32 s54, s58, 4096
  buffer_load_dwordx4 v[16:19], v14, s[32:35], s55 offen offset:0 sc1
  buffer_load_dwordx4 v[20:23], v14, s[32:35], s55 offen offset:1024 sc1
  buffer_load_dwordx4 v[24:27], v14, s[32:35], s55 offen offset:2048 sc1
  buffer_load_dwordx4 v[28:31], v14, s[32:35], s55 offen offset:3072 sc1
  s_cmp_eq_u32 s54, 20480
  s_cselect_b32 s58, 0, s54
  ds_read_b64_tr_b16 v[48:49], v13 offset:0
  ds_read_b64_tr_b16 v[50:51], v13 offset:768
  ds_read_b64_tr_b16 v[52:53], v13 offset:64
  ds_read_b64_tr_b16 v[54:55], v13 offset:832
  ds_read_b64_tr_b16 v[56:57], v13 offset:128
  ds_read_b64_tr_b16 v[58:59], v13 offset:896
  ds_read_b64_tr_b16 v[60:61], v13 offset:3072
  ds_read_b64_tr_b16 v[62:63], v13 offset:3840
  ds_read_b64_tr_b16 v[64:65], v13 offset:3136
  ds_read_b64_tr_b16 v[66:67], v13 offset:3904
  ds_read_b64_tr_b16 v[68:69], v13 offset:3200
  ds_read_b64_tr_b16 v[70:71], v13 offset:3968
  s_waitcnt lgkmcnt(6)
  v_mfma_f32_32x32x16_bf16 v[76:91], v[48:51], v[32:35], v[76:91]
  v_mfma_f32_32x32x16_bf16 v[92:107], v[52:55], v[32:35], v[92:107]
  v_mfma_f32_32x32x16_bf16 v[108:123], v[56:59], v[32:35], v[108:123]
  ds_read_b64_tr_b16 v[48:49], v13 offset:6144
  ds_read_b64_tr_b16 v[50:51], v13 offset:6912
  ds_read_b64_tr_b16 v[52:53], v13 offset:6208
  ds_read_b64_tr_b16 v[54:55], v13 offset:6976
  ds_read_b64_tr_b16 v[56:57], v13 offset:6272
  ds_read_b64_tr_b16 v[58:59], v13 offset:7040
  s_waitcnt lgkmcnt(6)
  v_mfma_f32_32x32x16_bf16 v[76:91], v[60:63], v[36:39], v[76:91]
  v_mfma_f32_32x32x16_bf16 v[92:107], v[64:67], v[36:39], v[92:107]
  v_mfma_f32_32x32x16_bf16 v[108:123], v[68:71], v[36:39], v[108:123]
  ds_read_b64_tr_b16 v[60:61], v13 offset:9216
  ds_read_b64_tr_b16 v[62:63], v13 offset:9984
  ds_read_b64_tr_b16 v[64:65], v13 offset:9280
  ds_read_b64_tr_b16 v[66:67], v13 offset:10048
  ds_read_b64_tr_b16 v[68:69], v13 offset:9344
  ds_read_b64_tr_b16 v[70:71], v13 offset:10112
  s_waitcnt lgkmcnt(6)
  v_mfma_f32_32x32x16_bf16 v[76:91], v[48:51], v[40:43], v[76:91]
  v_mfma_f32_32x32x16_bf16 v[92:107], v[52:55], v[40:43], v[92:107]
  v_mfma_f32_32x32x16_bf16 v[108:123], v[56:59], v[40:43], v[108:123]
  s_waitcnt lgkmcnt(0)
  v_mfma_f32_32x32x16_bf16 v[76:91], v[60:63], v[44:47], v[76:91]
  v_mfma_f32_32x32x16_bf16 v[92:107], v[64:67], v[44:47], v[92:107]
  v_mfma_f32_32x32x16_bf16 v[108:123], v[68:71], v[44:47], v[108:123]
  s_waitcnt vmcnt(0)
  s_barrier
  ds_read_b64_tr_b16 v[48:49], v13 offset:24576
  ds_read_b64_tr_b16 v[50:51], v13 offset:25344
  ds_read_b64_tr_b16 v[52:53], v13 offset:24640
  ds_read_b64_tr_b16 v[54:55], v13 offset:25408
  ds_read_b64_tr_b16 v[56:57], v13 offset:24704
  ds_read_b64_tr_b16 v[58:59], v13 offset:25472
  ds_read_b64_tr_b16 v[60:61], v13 offset:27648
  ds_read_b64_tr_b16 v[62:63], v13 offset:28416
  ds_read_b64_tr_b16 v[64:65], v13 offset:27712
  ds_read_b64_tr_b16 v[66:67], v13 offset:28480
  ds_read_b64_tr_b16 v[68:69], v13 offset:27776
  ds_read_b64_tr_b16 v[70:71], v13 offset:28544
  s_waitcnt lgkmcnt(6)
  v_mfma_f32_32x32x16_bf16 v[76:91], v[48:51], v[16:19], v[76:91]
  v_mfma_f32_32x32x16_bf16 v[92:107], v[52:55], v[16:19], v[92:107]
  v_mfma_f32_32x32x16_bf16 v[108:123], v[56:59], v[16:19], v[108:123]
  ds_read_b64_tr_b16 v[48:49], v13 offset:30720
  ds_read_b64_tr_b16 v[50:51], v13 offset:31488
  ds_read_b64_tr_b16 v[52:53], v13 offset:30784
  ds_read_b64_tr_b16 v[54:55], v13 offset:31552
  ds_read_b64_tr_b16 v[56:57], v13 offset:30848
  ds_read_b64_tr_b16 v[58:59], v13 offset:31616
  s_waitcnt lgkmcnt(6)
  v_mfma_f32_32x32x16_bf16 v[76:91], v[60:63], v[20:23], v[76:91]
  v_mfma_f32_32x32x16_bf16 v[92:107], v[64:67], v[20:23], v[92:107]
  v_mfma_f32_32x32x16_bf16 v[108:123], v[68:71], v[20:23], v[108:123]
  ds_read_b64_tr_b16 v[60:61], v13 offset:33792
  ds_read_b64_tr_b16 v[62:63], v13 offset:34560
  ds_read_b64_tr_b16 v[64:65], v13 offset:33856
  ds_read_b64_tr_b16 v[66:67], v13 offset:34624
  ds_read_b64_tr_b16 v[68:69], v13 offset:33920
  ds_read_b64_tr_b16 v[70:71], v13 offset:34688
  s_waitcnt lgkmcnt(6)
  v_mfma_f32_32x32x16_bf16 v[76:91], v[48:51], v[24:27], v[76:91]
  v_mfma_f32_32x32x16_bf16 v[92:107], v[52:55], v[24:27], v[92:107]
  v_mfma_f32_32x32x16_bf16 v[108:123], v[56:59], v[24:27], v[108:123]
  s_waitcnt lgkmcnt(0)
  v_mfma_f32_32x32x16_bf16 v[76:91], v[60:63], v[28:31], v[76:91]
  v_mfma_f32_32x32x16_bf16 v[92:107], v[64:67], v[28:31], v[92:107]
  v_mfma_f32_32x32x16_bf16 v[108:123], v[68:71], v[28:31], v[108:123]
  s_setprio 3
  s_and_b32 s54, s30, 3
  s_lshl_b32 s55, s52, 2
  s_add_u32 s54, s54, s55
  s_lshl_b32 s55, s54, 7
  s_add_u32 s55, s55, 2621440
  v_lshlrev_b32 v4, 2, v3
  buffer_load_dword v15, v4, s[32:35], s55 offen sc1
  v_mov_b32 v72, 81904
  ds_read_b32 v73, v72
  s_mul_i32 s55, s53, 192
  s_lshl_b32 s56, s60, 5
  s_add_u32 s55, s55, s56
  v_lshlrev_b32 v4, 3, v2
  buffer_load_dwordx2 v[16:17], v4, s[44:47], s55 offen offset:0
  buffer_load_dwordx2 v[18:19], v4, s[44:47], s55 offen offset:16
  buffer_load_dwordx2 v[20:21], v4, s[44:47], s55 offen offset:64
  buffer_load_dwordx2 v[22:23], v4, s[44:47], s55 offen offset:80
  buffer_load_dwordx2 v[24:25], v4, s[44:47], s55 offen offset:128
  buffer_load_dwordx2 v[26:27], v4, s[44:47], s55 offen offset:144
  s_mul_i32 s54, s54, 96
  s_mul_i32 s55, s53, 6
  s_add_u32 s54, s54, s55
  s_add_u32 s54, s54, s60
  s_lshl_b32 s99, s54, 10
  s_add_u32 s99, s99, 5570560
  s_barrier
  s_nop 3
  s_mul_i32 s54, s30, 6144
  v_add_u32 v5, s54, v14
  s_xor_b32 s54, s30, 4
  s_mul_i32 s54, s54, 6144
  v_add_u32 v6, s54, v14
  s_cmp_eq_u32 s60, 1
  s_cbranch_scc1 B1_x1
  ds_write_b128 v5, v[84:87] offset:0
  ds_write_b128 v5, v[88:91] offset:1024
  ds_write_b128 v5, v[100:103] offset:2048
  ds_write_b128 v5, v[104:107] offset:3072
  ds_write_b128 v5, v[116:119] offset:4096
  ds_write_b128 v5, v[120:123] offset:5120
  s_branch B1_x2
B1_x1:
  ds_write_b128 v5, v[76:79] offset:0
  ds_write_b128 v5, v[80:83] offset:1024
  ds_write_b128 v5, v[92:95] offset:2048
  ds_write_b128 v5, v[96:99] offset:3072
  ds_write_b128 v5, v[108:111] offset:4096
  ds_write_b128 v5, v[112:115] offset:5120
B1_x2:
  s_waitcnt lgkmcnt(0)
  s_barrier
  ds_read_b128 v[32:35], v6 offset:0
  ds_read_b128 v[36:39], v6 offset:1024
  ds_read_b128 v[40:43], v6 offset:2048
  ds_read_b128 v[44:47], v6 offset:3072
  ds_read_b128 v[48:51], v6 offset:4096
  ds_read_b128 v[52:55], v6 offset:5120
  s_waitcnt lgkmcnt(0) vmcnt(0)
  v_readfirstlane_b32 s31, v73
  s_cmp_eq_u32 s60, 1
  s_cbranch_scc1 B1_y1
  v_add_f32 v32, v32, v76
  v_add_f32 v33, v33, v77
  v_add_f32 v34, v34, v78
  v_add_f32 v35, v35, v79
  v_add_f32 v36, v36, v80
  v_add_f32 v37, v37, v81
  v_add_f32 v38, v38, v82
  v_add_f32 v39, v39, v83
  v_add_f32 v40, v40, v92
  v_add_f32 v41, v41, v93
  v_add_f32 v42, v42, v94
  v_add_f32 v43, v43, v95
  v_add_f32 v44, v44, v96
  v_add_f32 v45, v45, v97
  v_add_f32 v46, v46, v98
  v_add_f32 v47, v47, v99
  v_add_f32 v48, v48, v108
  v_add_f32 v49, v49, v109
  v_add_f32 v50, v50, v110
  v_add_f32 v51, v51, v111
  v_add_f32 v52, v52, v112
  v_add_f32 v53, v53, v113
  v_add_f32 v54, v54, v114
  v_add_f32 v55, v55, v115
  s_branch B1_y2
B1_y1:
  v_add_f32 v32, v32, v84
  v_add_f32 v33, v33, v85
  v_add_f32 v34, v34, v86
  v_add_f32 v35, v35, v87
  v_add_f32 v36, v36, v88
  v_add_f32 v37, v37, v89
  v_add_f32 v38, v38, v90
  v_add_f32 v39, v39, v91
  v_add_f32 v40, v40, v100
  v_add_f32 v41, v41, v101
  v_add_f32 v42, v42, v102
  v_add_f32 v43, v43, v103
  v_add_f32 v44, v44, v104
  v_add_f32 v45, v45, v105
  v_add_f32 v46, v46, v106
  v_add_f32 v47, v47, v107
  v_add_f32 v48, v48, v116
  v_add_f32 v49, v49, v117
  v_add_f32 v50, v50, v118
  v_add_f32 v51, v51, v119
  v_add_f32 v52, v52, v120
  v_add_f32 v53, v53, v121
  v_add_f32 v54, v54, v122
  v_add_f32 v55, v55, v123
B1_y2:
  v_lshlrev_b32 v56, 16, v16
  v_and_b32 v57, 0xffff0000, v16
  v_lshlrev_b32 v58, 16, v17
  v_and_b32 v59, 0xffff0000, v17
  v_fma_f32 v32, v32, v15, v56
  v_fma_f32 v33, v33, v15, v57
  v_fma_f32 v34, v34, v15, v58
  v_fma_f32 v35, v35, v15, v59
  v_max_f32 v32, 0, v32
  v_max_f32 v33, 0, v33
  v_max_f32 v34, 0, v34
  v_max_f32 v35, 0, v35
  v_mul_f32 v32, v32, v32
  v_mul_f32 v33, v33, v33
  v_mul_f32 v34, v34, v34
  v_mul_f32 v35, v35, v35
  v_lshlrev_b32 v56, 16, v18
  v_and_b32 v57, 0xffff0000, v18
  v_lshlrev_b32 v58, 16, v19
  v_and_b32 v59, 0xffff0000, v19
  v_fma_f32 v36, v36, v15, v56
  v_fma_f32 v37, v37, v15, v57
  v_fma_f32 v38, v38, v15, v58
  v_fma_f32 v39, v39, v15, v59
  v_max_f32 v36, 0, v36
  v_max_f32 v37, 0, v37
  v_max_f32 v38, 0, v38
  v_max_f32 v39, 0, v39
  v_mul_f32 v36, v36, v36
  v_mul_f32 v37, v37, v37
  v_mul_f32 v38, v38, v38
  v_mul_f32 v39, v39, v39
  v_cvt_pk_bf16_f32 v60, v32, v33
  v_cvt_pk_bf16_f32 v61, v34, v35
  v_cvt_pk_bf16_f32 v62, v36, v37
  v_cvt_pk_bf16_f32 v63, v38, v39
  v_lshlrev_b32 v56, 16, v20
  v_and_b32 v57, 0xffff0000, v20
  v_lshlrev_b32 v58, 16, v21
  v_and_b32 v59, 0xffff0000, v21
  v_fma_f32 v40, v40, v15, v56
  v_fma_f32 v41, v41, v15, v57
  v_fma_f32 v42, v42, v15, v58
  v_fma_f32 v43, v43, v15, v59
  v_max_f32 v40, 0, v40
  v_max_f32 v41, 0, v41
  v_max_f32 v42, 0, v42
  v_max_f32 v43, 0, v43
  v_mul_f32 v40, v40, v40
  v_mul_f32 v41, v41, v41
  v_mul_f32 v42, v42, v42
  v_mul_f32 v43, v43, v43
  v_lshlrev_b32 v56, 16, v22
  v_and_b32 v57, 0xffff0000, v22
  v_lshlrev_b32 v58, 16, v23
  v_and_b32 v59, 0xffff0000, v23
  v_fma_f32 v44, v44, v15, v56
  v_fma_f32 v45, v45, v15, v57
  v_fma_f32 v46, v46, v15, v58
  v_fma_f32 v47, v47, v15, v59
  v_max_f32 v44, 0, v44
  v_max_f32 v45, 0, v45
  v_max_f32 v46, 0, v46
  v_max_f32 v47, 0, v47
  v_mul_f32 v44, v44, v44
  v_mul_f32 v45, v45, v45
  v_mul_f32 v46, v46, v46
  v_mul_f32 v47, v47, v47
  v_cvt_pk_bf16_f32 v64, v40, v41
  v_cvt_pk_bf16_f32 v65, v42, v43
  v_cvt_pk_bf16_f32 v66, v44, v45
  v_cvt_pk_bf16_f32 v67, v46, v47
  v_lshlrev_b32 v56, 16, v24
  v_and_b32 v57, 0xffff0000, v24
  v_lshlrev_b32 v58, 16, v25
  v_and_b32 v59, 0xffff0000, v25
  v_fma_f32 v48, v48, v15, v56
  v_fma_f32 v49, v49, v15, v57
  v_fma_f32 v50, v50, v15, v58
  v_fma_f32 v51, v51, v15, v59
  v_max_f32 v48, 0, v48
  v_max_f32 v49, 0, v49
  v_max_f32 v50, 0, v50
  v_max_f32 v51, 0, v51
  v_mul_f32 v48, v48, v48
  v_mul_f32 v49, v49, v49
  v_mul_f32 v50, v50, v50
  v_mul_f32 v51, v51, v51
  v_lshlrev_b32 v56, 16, v26
  v_and_b32 v57, 0xffff0000, v26
  v_lshlrev_b32 v58, 16, v27
  v_and_b32 v59, 0xffff0000, v27
  v_fma_f32 v52, v52, v15, v56
  v_fma_f32 v53, v53, v15, v57
  v_fma_f32 v54, v54, v15, v58
  v_fma_f32 v55, v55, v15, v59
  v_max_f32 v52, 0, v52
  v_max_f32 v53, 0, v53
  v_max_f32 v54, 0, v54
  v_max_f32 v55, 0, v55
  v_mul_f32 v52, v52, v52
  v_mul_f32 v53, v53, v53
  v_mul_f32 v54, v54, v54
  v_mul_f32 v55, v55, v55
  v_cvt_pk_bf16_f32 v68, v48, v49
  v_cvt_pk_bf16_f32 v69, v50, v51
  v_cvt_pk_bf16_f32 v70, v52, v53
  v_cvt_pk_bf16_f32 v71, v54, v55
  v_add_u32 v4, 4096, v14
  buffer_store_dwordx4 v[60:63], v14, s[32:35], s99 offen sc1
  buffer_store_dwordx4 v[64:67], v14, s[32:35], s99 offen offset:2048 sc1
  buffer_store_dwordx4 v[68:71], v4, s[32:35], s99 offen sc1
  s_cmp_lg_u32 s30, 6
  s_cbranch_scc1 B1_nfw
  s_sub_u32 s54, s2, 256
  s_and_b32 s55, s54, 1
  s_lshl_b32 s55, s55, 1
  s_lshr_b32 s54, s54, 7
  s_add_u32 s54, s54, s55
  s_lshl_b32 s54, s54, 6
  v_lshlrev_b32 v4, 7, v1
  s_lshl_b32 s63, s54, 7
  s_add_u32 s63, s63, 114688
  s_mov_b32 s56, 200063
  s_mov_b64 s[100:101], exec
B2w_poll:
  s_and_b32 s62, s56, 63
  s_cmp_eq_u32 s62, 0
  s_cbranch_scc1 B2w_poll_atom
  buffer_load_dword v5, v4, s[36:39], s63 offen sc1
  s_branch B2w_poll_got
B2w_poll_atom:
  v_mov_b32 v5, 0
  buffer_atomic_add v5, v4, s[36:39], s63 offen sc0 sc1
B2w_poll_got:
  s_waitcnt vmcnt(0)
  v_cmp_ne_u32 vcc, s31, v5
  s_nop 1
  s_and_b64 exec, exec, vcc
  s_cbranch_execz B2w_poll_done
  s_sub_u32 s56, s56, 1
  s_cmp_eq_u32 s56, 0
  s_cbranch_scc1 B2w_poll_done
  s_sleep 6
  s_branch B2w_poll
B2w_poll_done:
  s_mov_b64 exec, s[100:101]
B1_nfw:
  s_waitcnt vmcnt(0)
  s_barrier
  s_cmp_lg_u32 s30, 0
  s_cbranch_scc1 B1_nf
  s_lshl_b32 s54, s52, 4
  s_add_u32 s54, s54, s53
  v_mov_b32 v4, s31
  v_mov_b32 v5, 0
  s_lshl_b32 s63, s54, 7
  s_add_u32 s63, s63, 81920
  s_mov_b64 s[100:101], exec
  s_mov_b64 exec, 1
  buffer_store_dword v4, v5, s[36:39], s63 offen sc1
  s_mov_b64 exec, s[100:101]
B1_nf:
  s_setprio 0
  s_sub_u32 s55, s2, 256
  s_bfe_u32 s52, s55, 0x20001
  s_lshl_b32 s52, s52, 4
  s_bfe_u32 s54, s55, 0x40003
  s_add_u32 s52, s52, s54
  s_and_b32 s53, s55, 1
  s_lshl_b32 s53, s53, 1
  s_lshr_b32 s54, s55, 7
  s_add_u32 s53, s53, s54
  v_lshlrev_b32 v14, 4, v1
  s_and_b32 s61, s52, 7
  s_min_u32 s56, s30, 4
  s_mul_i32 s54, s53, 5
  s_add_u32 s54, s54, s56
  s_mul_i32 s59, s54, 139264
  s_add_u32 s59, s59, 12320768
  s_lshl_b32 s54, s54, 6
  s_mov_b32 s48, s4
  s_mov_b32 s49, s5
  s_mov_b32 s50, 2621440
  s_mov_b32 s51, 0x00020000
  s_lshl_b32 s55, s52, 5
  v_add_u32 v4, s55, v3
  v_mul_u32_u24 v4, 1280, v4
  v_lshl_add_u32 v4, v2, 3, v4
  v_add_u32 v7, s54, v4
  buffer_load_dwordx2 v[48:49], v7, s[48:51], 0 offen offset:0
  buffer_load_dwordx2 v[50:51], v7, s[48:51], 0 offen offset:16
  buffer_load_dwordx2 v[52:53], v7, s[48:51], 0 offen offset:32
  buffer_load_dwordx2 v[54:55], v7, s[48:51], 0 offen offset:48
  s_mov_b32 s48, s22
  s_mov_b32 s49, s23
  s_mov_b32 s50, 1280
  s_mov_b32 s51, 0x00020000
  v_lshlrev_b32 v4, 3, v2
  buffer_load_dwordx2 v[56:57], v4, s[48:51], s54 offen offset:0
  buffer_load_dwordx2 v[58:59], v4, s[48:51], s54 offen offset:16
  buffer_load_dwordx2 v[60:61], v4, s[48:51], s54 offen offset:32
  buffer_load_dwordx2 v[62:63], v4, s[48:51], s54 offen offset:48
  v_mov_b32 v16, 0
  v_mov_b32 v17, 0
  v_mov_b32 v18, 0
  v_mov_b32 v19, 0
  v_mov_b32 v20, 0
  v_mov_b32 v21, 0
  v_mov_b32 v22, 0
  v_mov_b32 v23, 0
  v_mov_b32 v24, 0
  v_mov_b32 v25, 0
  v_mov_b32 v26, 0
  v_mov_b32 v27, 0
  v_mov_b32 v28, 0
  v_mov_b32 v29, 0
  v_mov_b32 v30, 0
  v_mov_b32 v31, 0
  s_cmp_ge_u32 s30, 4
  s_cbranch_scc1 B2_side
  s_lshl_b32 s57, s61, 13
  s_mov_b32 s98, 98304
  s_mov_b32 s99, 0
  s_add_u32 s55, s59, s57
  s_add_u32 s54, s57, 1024
  buffer_load_dwordx4 v[64:67], v14, s[32:35], s55 offen sc1
  s_cmp_eq_u32 s54, s98
  s_cselect_b32 s57, s99, s54
  s_add_u32 s55, s59, s57
  s_add_u32 s54, s57, 1024
  buffer_load_dwordx4 v[68:71], v14, s[32:35], s55 offen sc1
  s_cmp_eq_u32 s54, s98
  s_cselect_b32 s57, s99, s54
  s_add_u32 s55, s59, s57
  s_add_u32 s54, s57, 1024
  buffer_load_dwordx4 v[72:75], v14, s[32:35], s55 offen sc1
  s_cmp_eq_u32 s54, s98
  s_cselect_b32 s57, s99, s54
  s_add_u32 s55, s59, s57
  s_add_u32 s54, s57, 1024
  buffer_load_dwordx4 v[76:79], v14, s[32:35], s55 offen sc1
  s_cmp_eq_u32 s54, s98
  s_cselect_b32 s57, s99, s54
  s_add_u32 s55, s59, s57
  s_add_u32 s54, s57, 1024
  buffer_load_dwordx4 v[80:83], v14, s[32:35], s55 offen sc1
  s_cmp_eq_u32 s54, s98
  s_cselect_b32 s57, s99, s54
  s_add_u32 s55, s59, s57
  s_add_u32 s54, s57, 1024
  buffer_load_dwordx4 v[84:87], v14, s[32:35], s55 offen sc1
  s_cmp_eq_u32 s54, s98
  s_cselect_b32 s57, s99, s54
  s_add_u32 s55, s59, s57
  s_add_u32 s54, s57, 1024
  buffer_load_dwordx4 v[88:91], v14, s[32:35], s55 offen sc1
  s_cmp_eq_u32 s54, s98
  s_cselect_b32 s57, s99, s54
  s_add_u32 s55, s59, s57
  s_add_u32 s54, s57, 1024
  buffer_load_dwordx4 v[92:95], v14, s[32:35], s55 offen sc1
  s_cmp_eq_u32 s54, s98
  s_cselect_b32 s57, s99, s54
  s_add_u32 s55, s59, s57
  s_add_u32 s54, s57, 1024
  buffer_load_dwordx4 v[96:99], v14, s[32:35], s55 offen sc1
  s_cmp_eq_u32 s54, s98
  s_cselect_b32 s57, s99, s54
  s_add_u32 s55, s59, s57
  s_add_u32 s54, s57, 1024
  buffer_load_dwordx4 v[100:103], v14, s[32:35], s55 offen sc1
  s_cmp_eq_u32 s54, s98
  s_cselect_b32 s57, s99, s54
  s_add_u32 s55, s59, s57
  s_add_u32 s54, s57, 1024
  buffer_load_dwordx4 v[104:107], v14, s[32:35], s55 offen sc1
  s_cmp_eq_u32 s54, s98
  s_cselect_b32 s57, s99, s54
  s_add_u32 s55, s59, s57
  s_add_u32 s54, s57, 1024
  buffer_load_dwordx4 v[108:111], v14, s[32:35], s55 offen sc1
  s_cmp_eq_u32 s54, s98
  s_cselect_b32 s57, s99, s54
  s_add_u32 s55, s59, s57
  s_add_u32 s54, s57, 1024
  buffer_load_dwordx4 v[112:115], v14, s[32:35], s55 offen sc1
  s_cmp_eq_u32 s54, s98
  s_cselect_b32 s57, s99, s54
  s_add_u32 s55, s59, s57
  s_add_u32 s54, s57, 1024
  buffer_load_dwordx4 v[116:119], v14, s[32:35], s55 offen sc1
  s_cmp_eq_u32 s54, s98
  s_cselect_b32 s57, s99, s54
  s_add_u32 s55, s59, s57
  s_add_u32 s54, s57, 1024
  buffer_load_dwordx4 v[120:123], v14, s[32:35], s55 offen sc1
  s_cmp_eq_u32 s54, s98
  s_cselect_b32 s57, s99, s54
  s_add_u32 s55, s59, s57
  s_add_u32 s54, s57, 1024
  buffer_load_dwordx4 v[124:127], v14, s[32:35], s55 offen sc1
  s_cmp_eq_u32 s54, s98
  s_cselect_b32 s57, s99, s54
  s_barrier
  s_mov_b32 s60, 0
B2_p1:
  s_barrier
  s_lshl_b32 s54, s60, 1
  s_and_b32 s54, s54, 7
  s_lshl_b32 s54, s54, 13
  v_add_u32 v15, s54, v14
  ds_read_b128 v[32:35], v15 offset:0
  ds_read_b128 v[36:39], v15 offset:1024
  ds_read_b128 v[40:43], v15 offset:2048
  s_cmp_lg_u32 s60, 5
  s_cbranch_scc1 B2_p1n
  s_mul_i32 s57, s61, 5120
  s_add_u32 s57, s57, 98304
  s_mov_b32 s98, 139264
  s_mov_b32 s99, 98304
B2_p1n:
  ds_read_b128 v[44:47], v15 offset:3072
  s_waitcnt vmcnt(15) lgkmcnt(3)
  v_mfma_f32_32x32x16_bf16 v[16:31], v[64:67], v[32:35], v[16:31]
  s_add_u32 s55, s59, s57
  s_add_u32 s54, s57, 1024
  buffer_load_dwordx4 v[64:67], v14, s[32:35], s55 offen sc1
  s_cmp_eq_u32 s54, s98
  s_cselect_b32 s57, s99, s54
  ds_read_b128 v[32:35], v15 offset:4096
  s_waitcnt vmcnt(15) lgkmcnt(3)
  v_mfma_f32_32x32x16_bf16 v[16:31], v[68:71], v[36:39], v[16:31]
  s_add_u32 s55, s59, s57
  s_add_u32 s54, s57, 1024
  buffer_load_dwordx4 v[68:71], v14, s[32:35], s55 offen sc1
  s_cmp_eq_u32 s54, s98
  s_cselect_b32 s57, s99, s54
  ds_read_b128 v[36:39], v15 offset:5120
  s_waitcnt vmcnt(15) lgkmcnt(3)
  v_mfma_f32_32x32x16_bf16 v[16:31], v[72:75], v[40:43], v[16:31]
  s_add_u32 s55, s59, s57
  s_add_u32 s54, s57, 1024
  buffer_load_dwordx4 v[72:75], v14, s[32:35], s55 offen sc1
  s_cmp_eq_u32 s54, s98
  s_cselect_b32 s57, s99, s54
  ds_read_b128 v[40:43], v15 offset:6144
  s_waitcnt vmcnt(15) lgkmcnt(3)
  v_mfma_f32_32x32x16_bf16 v[16:31], v[76:79], v[44:47], v[16:31]
  s_add_u32 s55, s59, s57
  s_add_u32 s54, s57, 1024
  buffer_load_dwordx4 v[76:79], v14, s[32:35], s55 offen sc1
  s_cmp_eq_u32 s54, s98
  s_cselect_b32 s57, s99, s54
  ds_read_b128 v[44:47], v15 offset:7168
  s_waitcnt vmcnt(15) lgkmcnt(3)
  v_mfma_f32_32x32x16_bf16 v[16:31], v[80:83], v[32:35], v[16:31]
  s_add_u32 s55, s59, s57
  s_add_u32 s54, s57, 1024
  buffer_load_dwordx4 v[80:83], v14, s[32:35], s55 offen sc1
  s_cmp_eq_u32 s54, s98
  s_cselect_b32 s57, s99, s54
  s_waitcnt vmcnt(15) lgkmcnt(2)
  v_mfma_f32_32x32x16_bf16 v[16:31], v[84:87], v[36:39], v[16:31]
  s_add_u32 s55, s59, s57
  s_add_u32 s54, s57, 1024
  buffer_load_dwordx4 v[84:87], v14, s[32:35], s55 offen sc1
  s_cmp_eq_u32 s54, s98
  s_cselect_b32 s57, s99, s54
  s_waitcnt vmcnt(15) lgkmcnt(1)
  v_mfma_f32_32x32x16_bf16 v[16:31], v[88:91], v[40:43], v[16:31]
  s_add_u32 s55, s59, s57
  s_add_u32 s54, s57, 1024
  buffer_load_dwordx4 v[88:91], v14, s[32:35], s55 offen sc1
  s_cmp_eq_u32 s54, s98
  s_cselect_b32 s57, s99, s54
  s_waitcnt vmcnt(15) lgkmcnt(0)
  v_mfma_f32_32x32x16_bf16 v[16:31], v[92:95], v[44:47], v[16:31]
  s_add_u32 s55, s59, s57
  s_add_u32 s54, s57, 1024
  buffer_load_dwordx4 v[92:95], v14, s[32:35], s55 offen sc1
  s_cmp_eq_u32 s54, s98
  s_cselect_b32 s57, s99, s54
  s_barrier
  s_lshl_b32 s54, s60, 1
  s_add_u32 s54, s54, 1
  s_and_b32 s54, s54, 7
  s_lshl_b32 s54, s54, 13
  v_add_u32 v15, s54, v14
  ds_read_b128 v[32:35], v15 offset:0
  ds_read_b128 v[36:39], v15 offset:1024
  ds_read_b128 v[40:43], v15 offset:2048
  ds_read_b128 v[44:47], v15 offset:3072
  s_waitcnt vmcnt(15) lgkmcnt(3)
  v_mfma_f32_32x32x16_bf16 v[16:31], v[96:99], v[32:35], v[16:31]
  s_add_u32 s55, s59, s57
  s_add_u32 s54, s57, 1024
  buffer_load_dwordx4 v[96:99], v14, s[32:35], s55 offen sc1
  s_cmp_eq_u32 s54, s98
  s_cselect_b32 s57, s99, s54
  ds_read_b128 v[32:35], v15 offset:4096
  s_waitcnt vmcnt(15) lgkmcnt(3)
  v_mfma_f32_32x32x16_bf16 v[16:31], v[100:103], v[36:39], v[16:31]
  s_add_u32 s55, s59, s57
  s_add_u32 s54, s57, 1024
  buffer_load_dwordx4 v[100:103], v14, s[32:35], s55 offen sc1
  s_cmp_eq_u32 s54, s98
  s_cselect_b32 s57, s99, s54
  ds_read_b128 v[36:39], v15 offset:5120
  s_waitcnt vmcnt(15) lgkmcnt(3)
  v_mfma_f32_32x32x16_bf16 v[16:31], v[104:107], v[40:43], v[16:31]
  s_add_u32 s55, s59, s57
  s_add_u32 s54, s57, 1024
  buffer_load_dwordx4 v[104:107], v14, s[32:35], s55 offen sc1
  s_cmp_eq_u32 s54, s98
  s_cselect_b32 s57, s99, s54
  ds_read_b128 v[40:43], v15 offset:6144
  s_waitcnt vmcnt(15) lgkmcnt(3)
  v_mfma_f32_32x32x16_bf16 v[16:31], v[108:111], v[44:47], v[16:31]
  s_add_u32 s55, s59, s57
  s_add_u32 s54, s57, 1024
  buffer_load_dwordx4 v[108:111], v14, s[32:35], s55 offen sc1
  s_cmp_eq_u32 s54, s98
  s_cselect_b32 s57, s99, s54
  ds_read_b128 v[44:47], v15 offset:7168
  s_waitcnt vmcnt(15) lgkmcnt(3)
  v_mfma_f32_32x32x16_bf16 v[16:31], v[112:115], v[32:35], v[16:31]
  s_add_u32 s55, s59, s57
  s_add_u32 s54, s57, 1024
  buffer_load_dwordx4 v[112:115], v14, s[32:35], s55 offen sc1
  s_cmp_eq_u32 s54, s98
  s_cselect_b32 s57, s99, s54
  s_waitcnt vmcnt(15) lgkmcnt(2)
  v_mfma_f32_32x32x16_bf16 v[16:31], v[116:119], v[36:39], v[16:31]
  s_add_u32 s55, s59, s57
  s_add_u32 s54, s57, 1024
  buffer_load_dwordx4 v[116:119], v14, s[32:35], s55 offen sc1
  s_cmp_eq_u32 s54, s98
  s_cselect_b32 s57, s99, s54
  s_waitcnt vmcnt(15) lgkmcnt(1)
  v_mfma_f32_32x32x16_bf16 v[16:31], v[120:123], v[40:43], v[16:31]
  s_add_u32 s55, s59, s57
  s_add_u32 s54, s57, 1024
  buffer_load_dwordx4 v[120:123], v14, s[32:35], s55 offen sc1
  s_cmp_eq_u32 s54, s98
  s_cselect_b32 s57, s99, s54
  s_waitcnt vmcnt(15) lgkmcnt(0)
  v_mfma_f32_32x32x16_bf16 v[16:31], v[124:127], v[44:47], v[16:31]
  s_add_u32 s55, s59, s57
  s_add_u32 s54, s57, 1024
  buffer_load_dwordx4 v[124:127], v14, s[32:35], s55 offen sc1
  s_cmp_eq_u32 s54, s98
  s_cselect_b32 s57, s99, s54
  s_add_u32 s60, s60, 1
  s_cmp_lt_u32 s60, 6
  s_cbranch_scc1 B2_p1
  s_nop 11
  v_lshlrev_b32 v32, 16, v48
  v_and_b32 v33, 0xffff0000, v48
  v_lshlrev_b32 v34, 16, v49
  v_and_b32 v35, 0xffff0000, v49
  v_lshlrev_b32 v36, 16, v56
  v_and_b32 v37, 0xffff0000, v56
  v_lshlrev_b32 v38, 16, v57
  v_and_b32 v39, 0xffff0000, v57
  v_add_f32 v32, v32, v36
  v_add_f32 v33, v33, v37
  v_add_f32 v34, v34, v38
  v_add_f32 v35, v35, v39
  v_add_f32 v16, v16, v32
  v_add_f32 v17, v17, v33
  v_add_f32 v18, v18, v34
  v_add_f32 v19, v19, v35
  v_lshlrev_b32 v32, 16, v50
  v_and_b32 v33, 0xffff0000, v50
  v_lshlrev_b32 v34, 16, v51
  v_and_b32 v35, 0xffff0000, v51
  v_lshlrev_b32 v36, 16, v58
  v_and_b32 v37, 0xffff0000, v58
  v_lshlrev_b32 v38, 16, v59
  v_and_b32 v39, 0xffff0000, v59
  v_add_f32 v32, v32, v36
  v_add_f32 v33, v33, v37
  v_add_f32 v34, v34, v38
  v_add_f32 v35, v35, v39
  v_add_f32 v20, v20, v32
  v_add_f32 v21, v21, v33
  v_add_f32 v22, v22, v34
  v_add_f32 v23, v23, v35
  v_lshlrev_b32 v32, 16, v52
  v_and_b32 v33, 0xffff0000, v52
  v_lshlrev_b32 v34, 16, v53
  v_and_b32 v35, 0xffff0000, v53
  v_lshlrev_b32 v36, 16, v60
  v_and_b32 v37, 0xffff0000, v60
  v_lshlrev_b32 v38, 16, v61
  v_and_b32 v39, 0xffff0000, v61
  v_add_f32 v32, v32, v36
  v_add_f32 v33, v33, v37
  v_add_f32 v34, v34, v38
  v_add_f32 v35, v35, v39
  v_add_f32 v24, v24, v32
  v_add_f32 v25, v25, v33
  v_add_f32 v26, v26, v34
  v_add_f32 v27, v27, v35
  v_lshlrev_b32 v32, 16, v54
  v_and_b32 v33, 0xffff0000, v54
  v_lshlrev_b32 v34, 16, v55
  v_and_b32 v35, 0xffff0000, v55
  v_lshlrev_b32 v36, 16, v62
  v_and_b32 v37, 0xffff0000, v62
  v_lshlrev_b32 v38, 16, v63
  v_and_b32 v39, 0xffff0000, v63
  v_add_f32 v32, v32, v36
  v_add_f32 v33, v33, v37
  v_add_f32 v34, v34, v38
  v_add_f32 v35, v35, v39
  v_add_f32 v28, v28, v32
  v_add_f32 v29, v29, v33
  v_add_f32 v30, v30, v34
  v_add_f32 v31, v31, v35
  s_add_u32 s55, s59, s57
  s_add_u32 s54, s57, 1024
  buffer_load_dwordx4 v[32:35], v14, s[32:35], s55 offen sc1
  s_cmp_eq_u32 s54, s98
  s_cselect_b32 s57, s99, s54
  s_add_u32 s55, s59, s57
  s_add_u32 s54, s57, 1024
  buffer_load_dwordx4 v[36:39], v14, s[32:35], s55 offen sc1
  s_cmp_eq_u32 s54, s98
  s_cselect_b32 s57, s99, s54
  s_add_u32 s55, s59, s57
  s_add_u32 s54, s57, 1024
  buffer_load_dwordx4 v[40:43], v14, s[32:35], s55 offen sc1
  s_cmp_eq_u32 s54, s98
  s_cselect_b32 s57, s99, s54
  s_add_u32 s55, s59, s57
  s_add_u32 s54, s57, 1024
  buffer_load_dwordx4 v[44:47], v14, s[32:35], s55 offen sc1
  s_cmp_eq_u32 s54, s98
  s_cselect_b32 s57, s99, s54
  s_barrier
  s_branch B2_oload
B2_side:
  s_sub_u32 s56, s30, 4
  s_waitcnt vmcnt(0)
  s_cmp_lg_u32 s56, 1
  s_cbranch_scc1 B2_q_10
  v_mov_b32 v48, v50
  v_mov_b32 v49, v51
  v_mov_b32 v56, v58
  v_mov_b32 v57, v59
B2_q_10:
  s_cmp_lg_u32 s56, 2
  s_cbranch_scc1 B2_q_11
  v_mov_b32 v48, v52
  v_mov_b32 v49, v53
  v_mov_b32 v56, v60
  v_mov_b32 v57, v61
B2_q_11:
  s_cmp_lg_u32 s56, 3
  s_cbranch_scc1 B2_q_12
  v_mov_b32 v48, v54
  v_mov_b32 v49, v55
  v_mov_b32 v56, v62
  v_mov_b32 v57, v63
B2_q_12:
  v_mov_b32 v40, 0
  v_mov_b32 v41, 0
  v_mov_b32 v42, 0
  v_mov_b32 v43, 0
  v_lshlrev_b32 v32, 16, v48
  v_and_b32 v33, 0xffff0000, v48
  v_lshlrev_b32 v34, 16, v49
  v_and_b32 v35, 0xffff0000, v49
  v_lshlrev_b32 v36, 16, v56
  v_and_b32 v37, 0xffff0000, v56
  v_lshlrev_b32 v38, 16, v57
  v_and_b32 v39, 0xffff0000, v57
  v_add_f32 v32, v32, v36
  v_add_f32 v33, v33, v37
  v_add_f32 v34, v34, v38
  v_add_f32 v35, v35, v39
  v_add_f32 v40, v40, v32
  v_add_f32 v41, v41, v33
  v_add_f32 v42, v42, v34
  v_add_f32 v43, v43, v35
  s_lshl_b32 s99, s56, 11
  s_lshl_b32 s57, s61, 13
  s_add_u32 s57, s57, s99
  s_add_u32 s98, s99, 98304
  s_add_u32 s55, s59, s57
  s_add_u32 s54, s57, 8192
  buffer_load_dwordx4 v[64:67], v14, s[32:35], s55 offen sc1
  buffer_load_dwordx4 v[68:71], v14, s[32:35], s55 offen offset:1024 sc1
  s_cmp_eq_u32 s54, s98
  s_cselect_b32 s57, s99, s54
  s_add_u32 s55, s59, s57
  s_add_u32 s54, s57, 8192
  buffer_load_dwordx4 v[72:75], v14, s[32:35], s55 offen sc1
  buffer_load_dwordx4 v[76:79], v14, s[32:35], s55 offen offset:1024 sc1
  s_cmp_eq_u32 s54, s98
  s_cselect_b32 s57, s99, s54
  s_add_u32 s55, s59, s57
  s_add_u32 s54, s57, 8192
  buffer_load_dwordx4 v[80:83], v14, s[32:35], s55 offen sc1
  buffer_load_dwordx4 v[84:87], v14, s[32:35], s55 offen offset:1024 sc1
  s_cmp_eq_u32 s54, s98
  s_cselect_b32 s57, s99, s54
  s_add_u32 s55, s59, s57
  s_add_u32 s54, s57, 8192
  buffer_load_dwordx4 v[88:91], v14, s[32:35], s55 offen sc1
  buffer_load_dwordx4 v[92:95], v14, s[32:35], s55 offen offset:1024 sc1
  s_cmp_eq_u32 s54, s98
  s_cselect_b32 s57, s99, s54
  s_cmp_lg_u32 s30, 7
  s_cbranch_scc1 B2_nph
  s_lshr_b32 s54, s52, 2
  s_lshl_b32 s54, s54, 4
  v_lshlrev_b32 v4, 7, v1
  s_lshl_b32 s63, s54, 7
  s_add_u32 s63, s63, 81920
  s_mov_b32 s56, 200063
  s_mov_b64 s[100:101], exec
  s_mov_b32 exec_lo, 65535
  s_mov_b32 exec_hi, 0
B2h_poll:
  s_and_b32 s62, s56, 63
  s_cmp_eq_u32 s62, 0
  s_cbranch_scc1 B2h_poll_atom
  buffer_load_dword v5, v4, s[36:39], s63 offen sc1
  s_branch B2h_poll_got
B2h_poll_atom:
  v_mov_b32 v5, 0
  buffer_atomic_add v5, v4, s[36:39], s63 offen sc0 sc1
B2h_poll_got:
  s_waitcnt vmcnt(0)
  v_cmp_ne_u32 vcc, s31, v5
  s_nop 1
  s_and_b64 exec, exec, vcc
  s_cbranch_execz B2h_poll_done
  s_sub_u32 s56, s56, 1
  s_cmp_eq_u32 s56, 0
  s_cbranch_scc1 B2h_poll_done
  s_sleep 2
  s_branch B2h_poll
B2h_poll_done:
  s_mov_b64 exec, s[100:101]
B2_nph:
  s_barrier
  s_sub_u32 s56, s30, 4
  s_mul_i32 s54, s52, 98304
  s_add_u32 s63, s54, 5570560
  s_lshl_b32 s97, s56, 11
  s_add_u32 s63, s63, s97
  s_lshl_b32 s58, s61, 13
  v_add_u32 v9, s97, v14
  s_add_u32 m0, s97, 0
  s_add_u32 s55, s63, s58
  s_add_u32 s54, s58, 8192
  buffer_load_dwordx4 v14, s[32:35], s55 offen offset:0 sc1 lds
  buffer_load_dwordx4 v14, s[32:35], s55 offen offset:1024 sc1 lds
  s_cmp_eq_u32 s54, 98304
  s_cselect_b32 s58, 0, s54
  s_add_u32 m0, s97, 8192
  s_add_u32 s55, s63, s58
  s_add_u32 s54, s58, 8192
  buffer_load_dwordx4 v14, s[32:35], s55 offen offset:0 sc1 lds
  buffer_load_dwordx4 v14, s[32:35], s55 offen offset:1024 sc1 lds
  s_cmp_eq_u32 s54, 98304
  s_cselect_b32 s58, 0, s54
  s_add_u32 m0, s97, 16384
  s_add_u32 s55, s63, s58
  s_add_u32 s54, s58, 8192
  buffer_load_dwordx4 v14, s[32:35], s55 offen offset:0 sc1 lds
  buffer_load_dwordx4 v14, s[32:35], s55 offen offset:1024 sc1 lds
  s_cmp_eq_u32 s54, 98304
  s_cselect_b32 s58, 0, s54
  s_add_u32 m0, s97, 24576
  s_add_u32 s55, s63, s58
  s_add_u32 s54, s58, 8192
  buffer_load_dwordx4 v14, s[32:35], s55 offen offset:0 sc1 lds
  buffer_load_dwordx4 v14, s[32:35], s55 offen offset:1024 sc1 lds
  s_cmp_eq_u32 s54, 98304
  s_cselect_b32 s58, 0, s54
  s_add_u32 m0, s97, 32768
  s_add_u32 s55, s63, s58
  s_add_u32 s54, s58, 8192
  buffer_load_dwordx4 v14, s[32:35], s55 offen offset:0 sc1 lds
  buffer_load_dwordx4 v14, s[32:35], s55 offen offset:1024 sc1 lds
  s_cmp_eq_u32 s54, 98304
  s_cselect_b32 s58, 0, s54
  s_add_u32 m0, s97, 40960
  s_add_u32 s55, s63, s58
  s_add_u32 s54, s58, 8192
  buffer_load_dwordx4 v14, s[32:35], s55 offen offset:0 sc1 lds
  buffer_load_dwordx4 v14, s[32:35], s55 offen offset:1024 sc1 lds
  s_cmp_eq_u32 s54, 98304
  s_cselect_b32 s58, 0, s54
  s_waitcnt vmcnt(10)
  s_barrier
  s_add_u32 m0, s97, 49152
  s_add_u32 s55, s63, s58
  s_add_u32 s54, s58, 8192
  buffer_load_dwordx4 v14, s[32:35], s55 offen offset:0 sc1 lds
  buffer_load_dwordx4 v14, s[32:35], s55 offen offset:1024 sc1 lds
  s_cmp_eq_u32 s54, 98304
  s_cselect_b32 s58, 0, s54
  ds_read_b128 v[48:51], v9 offset:0
  ds_read_b128 v[52:55], v9 offset:1024
  s_waitcnt lgkmcnt(1)
  v_mfma_f32_32x32x16_bf16 v[16:31], v[64:67], v[48:51], v[16:31]
  s_waitcnt lgkmcnt(0)
  v_mfma_f32_32x32x16_bf16 v[16:31], v[68:71], v[52:55], v[16:31]
  s_add_u32 s55, s59, s57
  s_add_u32 s54, s57, 8192
  buffer_load_dwordx4 v[64:67], v14, s[32:35], s55 offen sc1
  buffer_load_dwordx4 v[68:71], v14, s[32:35], s55 offen offset:1024 sc1
  s_cmp_eq_u32 s54, s98
  s_cselect_b32 s57, s99, s54
  s_waitcnt vmcnt(12)
  s_barrier
  s_add_u32 m0, s97, 57344
  s_add_u32 s55, s63, s58
  s_add_u32 s54, s58, 8192
  buffer_load_dwordx4 v14, s[32:35], s55 offen offset:0 sc1 lds
  buffer_load_dwordx4 v14, s[32:35], s55 offen offset:1024 sc1 lds
  s_cmp_eq_u32 s54, 98304
  s_cselect_b32 s58, 0, s54
  ds_read_b128 v[48:51], v9 offset:8192
  ds_read_b128 v[52:55], v9 offset:9216
  s_waitcnt lgkmcnt(1)
  v_mfma_f32_32x32x16_bf16 v[16:31], v[72:75], v[48:51], v[16:31]
  s_waitcnt lgkmcnt(0)
  v_mfma_f32_32x32x16_bf16 v[16:31], v[76:79], v[52:55], v[16:31]
  s_add_u32 s55, s59, s57
  s_add_u32 s54, s57, 8192
  buffer_load_dwordx4 v[72:75], v14, s[32:35], s55 offen sc1
  buffer_load_dwordx4 v[76:79], v14, s[32:35], s55 offen offset:1024 sc1
  s_cmp_eq_u32 s54, s98
  s_cselect_b32 s57, s99, s54
  s_waitcnt vmcnt(14)
  s_barrier
  s_add_u32 m0, s97, 0
  s_add_u32 s55, s63, s58
  s_add_u32 s54, s58, 8192
  buffer_load_dwordx4 v14, s[32:35], s55 offen offset:0 sc1 lds
  buffer_load_dwordx4 v14, s[32:35], s55 offen offset:1024 sc1 lds
  s_cmp_eq_u32 s54, 98304
  s_cselect_b32 s58, 0, s54
  ds_read_b128 v[48:51], v9 offset:16384
  ds_read_b128 v[52:55], v9 offset:17408
  s_waitcnt lgkmcnt(1)
  v_mfma_f32_32x32x16_bf16 v[16:31], v[80:83], v[48:51], v[16:31]
  s_waitcnt lgkmcnt(0)
  v_mfma_f32_32x32x16_bf16 v[16:31], v[84:87], v[52:55], v[16:31]
  s_add_u32 s55, s59, s57
  s_add_u32 s54, s57, 8192
  buffer_load_dwordx4 v[80:83], v14, s[32:35], s55 offen sc1
  buffer_load_dwordx4 v[84:87], v14, s[32:35], s55 offen offset:1024 sc1
  s_cmp_eq_u32 s54, s98
  s_cselect_b32 s57, s99, s54
  s_waitcnt vmcnt(16)
  s_barrier
  s_add_u32 m0, s97, 8192
  s_add_u32 s55, s63, s58
  s_add_u32 s54, s58, 8192
  buffer_load_dwordx4 v14, s[32:35], s55 offen offset:0 sc1 lds
  buffer_load_dwordx4 v14, s[32:35], s55 offen offset:1024 sc1 lds
  s_cmp_eq_u32 s54, 98304
  s_cselect_b32 s58, 0, s54
  ds_read_b128 v[48:51], v9 offset:24576
  ds_read_b128 v[52:55], v9 offset:25600
  s_waitcnt lgkmcnt(1)
  v_mfma_f32_32x32x16_bf16 v[16:31], v[88:91], v[48:51], v[16:31]
  s_waitcnt lgkmcnt(0)
  v_mfma_f32_32x32x16_bf16 v[16:31], v[92:95], v[52:55], v[16:31]
  s_add_u32 s55, s59, s57
  s_add_u32 s54, s57, 8192
  buffer_load_dwordx4 v[88:91], v14, s[32:35], s55 offen sc1
  buffer_load_dwordx4 v[92:95], v14, s[32:35], s55 offen offset:1024 sc1
  s_cmp_eq_u32 s54, s98
  s_cselect_b32 s57, s99, s54
  s_waitcnt vmcnt(12)
  s_barrier
  s_add_u32 m0, s97, 16384
  s_add_u32 s55, s63, s58
  s_add_u32 s54, s58, 8192
  buffer_load_dwordx4 v14, s[32:35], s55 offen offset:0 sc1 lds
  buffer_load_dwordx4 v14, s[32:35], s55 offen offset:1024 sc1 lds
  s_cmp_eq_u32 s54, 98304
  s_cselect_b32 s58, 0, s54
  ds_read_b128 v[48:51], v9 offset:32768
  ds_read_b128 v[52:55], v9 offset:33792
  s_waitcnt lgkmcnt(1)
  v_mfma_f32_32x32x16_bf16 v[16:31], v[64:67], v[48:51], v[16:31]
  s_waitcnt lgkmcnt(0)
  v_mfma_f32_32x32x16_bf16 v[16:31], v[68:71], v[52:55], v[16:31]
  s_add_u32 s55, s59, s57
  s_add_u32 s54, s57, 8192
  buffer_load_dwordx4 v[64:67], v14, s[32:35], s55 offen sc1
  buffer_load_dwordx4 v[68:71], v14, s[32:35], s55 offen offset:1024 sc1
  s_cmp_eq_u32 s54, s98
  s_cselect_b32 s57, s99, s54
  s_waitcnt vmcnt(12)
  s_barrier
  s_add_u32 m0, s97, 24576
  s_add_u32 s55, s63, s58
  s_add_u32 s54, s58, 8192
  buffer_load_dwordx4 v14, s[32:35], s55 offen offset:0 sc1 lds
  buffer_load_dwordx4 v14, s[32:35], s55 offen offset:1024 sc1 lds
  s_cmp_eq_u32 s54, 98304
  s_cselect_b32 s58, 0, s54
  ds_read_b128 v[48:51], v9 offset:40960
  ds_read_b128 v[52:55], v9 offset:41984
  s_waitcnt lgkmcnt(1)
  v_mfma_f32_32x32x16_bf16 v[16:31], v[72:75], v[48:51], v[16:31]
  s_waitcnt lgkmcnt(0)
  v_mfma_f32_32x32x16_bf16 v[16:31], v[76:79], v[52:55], v[16:31]
  s_add_u32 s55, s59, s57
  s_add_u32 s54, s57, 8192
  buffer_load_dwordx4 v[72:75], v14, s[32:35], s55 offen sc1
  buffer_load_dwordx4 v[76:79], v14, s[32:35], s55 offen offset:1024 sc1
  s_cmp_eq_u32 s54, s98
  s_cselect_b32 s57, s99, s54
  s_waitcnt vmcnt(12)
  s_barrier
  ds_read_b128 v[48:51], v9 offset:49152
  ds_read_b128 v[52:55], v9 offset:50176
  s_waitcnt lgkmcnt(1)
  v_mfma_f32_32x32x16_bf16 v[16:31], v[80:83], v[48:51], v[16:31]
  s_waitcnt lgkmcnt(0)
  v_mfma_f32_32x32x16_bf16 v[16:31], v[84:87], v[52:55], v[16:31]
  s_add_u32 s55, s59, s57
  s_add_u32 s54, s57, 8192
  buffer_load_dwordx4 v[80:83], v14, s[32:35], s55 offen sc1
  buffer_load_dwordx4 v[84:87], v14, s[32:35], s55 offen offset:1024 sc1
  s_cmp_eq_u32 s54, s98
  s_cselect_b32 s57, s99, s54
  s_waitcnt vmcnt(10)
  s_barrier
  ds_read_b128 v[48:51], v9 offset:57344
  ds_read_b128 v[52:55], v9 offset:58368
  s_waitcnt lgkmcnt(1)
  v_mfma_f32_32x32x16_bf16 v[16:31], v[88:91], v[48:51], v[16:31]
  s_waitcnt lgkmcnt(0)
  v_mfma_f32_32x32x16_bf16 v[16:31], v[92:95], v[52:55], v[16:31]
  s_add_u32 s55, s59, s57
  s_add_u32 s54, s57, 8192
  buffer_load_dwordx4 v[88:91], v14, s[32:35], s55 offen sc1
  buffer_load_dwordx4 v[92:95], v14, s[32:35], s55 offen offset:1024 sc1
  s_cmp_eq_u32 s54, s98
  s_cselect_b32 s57, s99, s54
  s_waitcnt vmcnt(8)
  s_barrier
  ds_read_b128 v[48:51], v9 offset:0
  ds_read_b128 v[52:55], v9 offset:1024
  s_waitcnt lgkmcnt(1)
  v_mfma_f32_32x32x16_bf16 v[16:31], v[64:67], v[48:51], v[16:31]
  s_waitcnt lgkmcnt(0)
  v_mfma_f32_32x32x16_bf16 v[16:31], v[68:71], v[52:55], v[16:31]
  s_waitcnt vmcnt(4)
  s_barrier
  ds_read_b128 v[48:51], v9 offset:8192
  ds_read_b128 v[52:55], v9 offset:9216
  s_waitcnt lgkmcnt(1)
  v_mfma_f32_32x32x16_bf16 v[16:31], v[72:75], v[48:51], v[16:31]
  s_waitcnt lgkmcnt(0)
  v_mfma_f32_32x32x16_bf16 v[16:31], v[76:79], v[52:55], v[16:31]
  s_waitcnt vmcnt(2)
  s_barrier
  ds_read_b128 v[48:51], v9 offset:16384
  ds_read_b128 v[52:55], v9 offset:17408
  s_waitcnt lgkmcnt(1)
  v_mfma_f32_32x32x16_bf16 v[16:31], v[80:83], v[48:51], v[16:31]
  s_waitcnt lgkmcnt(0)
  v_mfma_f32_32x32x16_bf16 v[16:31], v[84:87], v[52:55], v[16:31]
  s_waitcnt vmcnt(0)
  s_barrier
  ds_read_b128 v[48:51], v9 offset:24576
  ds_read_b128 v[52:55], v9 offset:25600
  s_waitcnt lgkmcnt(1)
  v_mfma_f32_32x32x16_bf16 v[16:31], v[88:91], v[48:51], v[16:31]
  s_waitcnt lgkmcnt(0)
  v_mfma_f32_32x32x16_bf16 v[16:31], v[92:95], v[52:55], v[16:31]
  s_sub_u32 s56, s30, 4
  s_lshl_b32 s56, s56, 1
  s_mul_i32 s62, s61, 5
  s_add_u32 s62, s62, s56
  s_add_u32 s54, s62, 0
  s_cmp_ge_u32 s54, 40
  s_cselect_b32 s55, 40, 0
  s_sub_u32 s54, s54, s55
  s_add_u32 s54, s54, 96
  s_lshl_b32 s54, s54, 10
  s_add_u32 s54, s54, s59
  buffer_load_dwordx4 v[64:67], v14, s[32:35], s54 offen sc1
  s_add_u32 s54, s62, 1
  s_cmp_ge_u32 s54, 40
  s_cselect_b32 s55, 40, 0
  s_sub_u32 s54, s54, s55
  s_add_u32 s54, s54, 96
  s_lshl_b32 s54, s54, 10
  s_add_u32 s54, s54, s59
  buffer_load_dwordx4 v[68:71], v14, s[32:35], s54 offen sc1
  s_add_u32 s54, s62, 8
  s_cmp_ge_u32 s54, 40
  s_cselect_b32 s55, 40, 0
  s_sub_u32 s54, s54, s55
  s_add_u32 s54, s54, 96
  s_lshl_b32 s54, s54, 10
  s_add_u32 s54, s54, s59
  buffer_load_dwordx4 v[72:75], v14, s[32:35], s54 offen sc1
  s_add_u32 s54, s62, 9
  s_cmp_ge_u32 s54, 40
  s_cselect_b32 s55, 40, 0
  s_sub_u32 s54, s54, s55
  s_add_u32 s54, s54, 96
  s_lshl_b32 s54, s54, 10
  s_add_u32 s54, s54, s59
  buffer_load_dwordx4 v[76:79], v14, s[32:35], s54 offen sc1
  s_add_u32 s54, s62, 16
  s_cmp_ge_u32 s54, 40
  s_cselect_b32 s55, 40, 0
  s_sub_u32 s54, s54, s55
  s_add_u32 s54, s54, 96
  s_lshl_b32 s54, s54, 10
  s_add_u32 s54, s54, s59
  buffer_load_dwordx4 v[80:83], v14, s[32:35], s54 offen sc1
  s_add_u32 s54, s62, 17
  s_cmp_ge_u32 s54, 40
  s_cselect_b32 s55, 40, 0
  s_sub_u32 s54, s54, s55
  s_add_u32 s54, s54, 96
  s_lshl_b32 s54, s54, 10
  s_add_u32 s54, s54, s59
  buffer_load_dwordx4 v[84:87], v14, s[32:35], s54 offen sc1
  s_add_u32 s54, s62, 24
  s_cmp_ge_u32 s54, 40
  s_cselect_b32 s55, 40, 0
  s_sub_u32 s54, s54, s55
  s_add_u32 s54, s54, 96
  s_lshl_b32 s54, s54, 10
  s_add_u32 s54, s54, s59
  buffer_load_dwordx4 v[88:91], v14, s[32:35], s54 offen sc1
  s_add_u32 s54, s62, 25
  s_cmp_ge_u32 s54, 40
  s_cselect_b32 s55, 40, 0
  s_sub_u32 s54, s54, s55
  s_add_u32 s54, s54, 96
  s_lshl_b32 s54, s54, 10
  s_add_u32 s54, s54, s59
  buffer_load_dwordx4 v[92:95], v14, s[32:35], s54 offen sc1
  s_add_u32 s54, s62, 32
  s_cmp_ge_u32 s54, 40
  s_cselect_b32 s55, 40, 0
  s_sub_u32 s54, s54, s55
  s_add_u32 s54, s54, 96
  s_lshl_b32 s54, s54, 10
  s_add_u32 s54, s54, s59
  buffer_load_dwordx4 v[96:99], v14, s[32:35], s54 offen sc1
  s_add_u32 s54, s62, 33
  s_cmp_ge_u32 s54, 40
  s_cselect_b32 s55, 40, 0
  s_sub_u32 s54, s54, s55
  s_add_u32 s54, s54, 96
  s_lshl_b32 s54, s54, 10
  s_add_u32 s54, s54, s59
  buffer_load_dwordx4 v[100:103], v14, s[32:35], s54 offen sc1
  s_cmp_lg_u32 s30, 7
  s_cbranch_scc1 B2_np2
  s_lshl_b32 s54, s52, 5
  v_lshlrev_b32 v4, 7, v1
  s_lshl_b32 s63, s54, 7
  s_add_u32 s63, s63, 147456
  s_mov_b32 s56, 200063
  s_mov_b64 s[100:101], exec
  s_mov_b32 exec_lo, -1
  s_mov_b32 exec_hi, 0
B2o_poll:
  s_and_b32 s62, s56, 63
  s_cmp_eq_u32 s62, 0
  s_cbranch_scc1 B2o_poll_atom
  buffer_load_dword v5, v4, s[36:39], s63 offen sc1
  s_branch B2o_poll_got
B2o_poll_atom:
  v_mov_b32 v5, 0
  buffer_atomic_add v5, v4, s[36:39], s63 offen sc0 sc1
B2o_poll_got:
  s_waitcnt vmcnt(0)
  v_cmp_ne_u32 vcc, s31, v5
  s_nop 1
  s_and_b64 exec, exec, vcc
  s_cbranch_execz B2o_poll_done
  s_sub_u32 s56, s56, 1
  s_cmp_eq_u32 s56, 0
  s_cbranch_scc1 B2o_poll_done
  s_sleep 2
  s_branch B2o_poll
B2o_poll_done:
  s_mov_b64 exec, s[100:101]
B2_np2:
  s_barrier
B2_oload:
  s_mul_i32 s63, s52, 40960
  s_add_u32 s63, s63, 2949120
  s_mul_i32 s62, s61, 5
  s_mul_i32 s54, s30, 5
  s_add_u32 s54, s54, 0
  s_add_u32 s55, s54, s62
  s_cmp_ge_u32 s55, 40
  s_cselect_b32 s60, 40, 0
  s_sub_u32 s55, s55, s60
  s_lshl_b32 s55, s55, 10
  s_add_u32 s55, s55, s63
  s_lshl_b32 m0, s54, 10
  s_nop 0
  buffer_load_dwordx4 v14, s[32:35], s55 offen sc1 lds
  s_mul_i32 s54, s30, 5
  s_add_u32 s54, s54, 1
  s_add_u32 s55, s54, s62
  s_cmp_ge_u32 s55, 40
  s_cselect_b32 s60, 40, 0
  s_sub_u32 s55, s55, s60
  s_lshl_b32 s55, s55, 10
  s_add_u32 s55, s55, s63
  s_lshl_b32 m0, s54, 10
  s_nop 0
  buffer_load_dwordx4 v14, s[32:35], s55 offen sc1 lds
  s_mul_i32 s54, s30, 5
  s_add_u32 s54, s54, 2
  s_add_u32 s55, s54, s62
  s_cmp_ge_u32 s55, 40
  s_cselect_b32 s60, 40, 0
  s_sub_u32 s55, s55, s60
  s_lshl_b32 s55, s55, 10
  s_add_u32 s55, s55, s63
  s_lshl_b32 m0, s54, 10
  s_nop 0
  buffer_load_dwordx4 v14, s[32:35], s55 offen sc1 lds
  s_mul_i32 s54, s30, 5
  s_add_u32 s54, s54, 3
  s_add_u32 s55, s54, s62
  s_cmp_ge_u32 s55, 40
  s_cselect_b32 s60, 40, 0
  s_sub_u32 s55, s55, s60
  s_lshl_b32 s55, s55, 10
  s_add_u32 s55, s55, s63
  s_lshl_b32 m0, s54, 10
  s_nop 0
  buffer_load_dwordx4 v14, s[32:35], s55 offen sc1 lds
  s_mul_i32 s54, s30, 5
  s_add_u32 s54, s54, 4
  s_add_u32 s55, s54, s62
  s_cmp_ge_u32 s55, 40
  s_cselect_b32 s60, 40, 0
  s_sub_u32 s55, s55, s60
  s_lshl_b32 s55, s55, 10
  s_add_u32 s55, s55, s63
  s_lshl_b32 m0, s54, 10
  s_nop 0
  buffer_load_dwordx4 v14, s[32:35], s55 offen sc1 lds
  s_waitcnt vmcnt(0)
  s_barrier
  s_cmp_ge_u32 s30, 4
  s_cbranch_scc1 B2_side2
  ds_read_b128 v[48:51], v14 offset:0
  ds_read_b128 v[52:55], v14 offset:1024
  ds_read_b128 v[56:59], v14 offset:2048
  ds_read_b128 v[60:63], v14 offset:3072
  s_waitcnt lgkmcnt(3)
  v_mfma_f32_32x32x16_bf16 v[16:31], v[64:67], v[48:51], v[16:31]
  s_add_u32 s55, s59, s57
  s_add_u32 s54, s57, 1024
  buffer_load_dwordx4 v[64:67], v14, s[32:35], s55 offen sc1
  s_cmp_eq_u32 s54, s98
  s_cselect_b32 s57, s99, s54
  ds_read_b128 v[48:51], v14 offset:4096
  s_waitcnt lgkmcnt(3)
  v_mfma_f32_32x32x16_bf16 v[16:31], v[68:71], v[52:55], v[16:31]
  s_add_u32 s55, s59, s57
  s_add_u32 s54, s57, 1024
  buffer_load_dwordx4 v[68:71], v14, s[32:35], s55 offen sc1
  s_cmp_eq_u32 s54, s98
  s_cselect_b32 s57, s99, s54
  ds_read_b128 v[52:55], v14 offset:5120
  s_waitcnt lgkmcnt(3)
  v_mfma_f32_32x32x16_bf16 v[16:31], v[72:75], v[56:59], v[16:31]
  s_add_u32 s55, s59, s57
  s_add_u32 s54, s57, 1024
  buffer_load_dwordx4 v[72:75], v14, s[32:35], s55 offen sc1
  s_cmp_eq_u32 s54, s98
  s_cselect_b32 s57, s99, s54
  ds_read_b128 v[56:59], v14 offset:6144
  s_waitcnt lgkmcnt(3)
  v_mfma_f32_32x32x16_bf16 v[16:31], v[76:79], v[60:63], v[16:31]
  s_add_u32 s55, s59, s57
  s_add_u32 s54, s57, 1024
  buffer_load_dwordx4 v[76:79], v14, s[32:35], s55 offen sc1
  s_cmp_eq_u32 s54, s98
  s_cselect_b32 s57, s99, s54
  ds_read_b128 v[60:63], v14 offset:7168
  s_waitcnt lgkmcnt(3)
  v_mfma_f32_32x32x16_bf16 v[16:31], v[80:83], v[48:51], v[16:31]
  s_add_u32 s55, s59, s57
  s_add_u32 s54, s57, 1024
  buffer_load_dwordx4 v[80:83], v14, s[32:35], s55 offen sc1
  s_cmp_eq_u32 s54, s98
  s_cselect_b32 s57, s99, s54
  ds_read_b128 v[48:51], v14 offset:8192
  s_waitcnt lgkmcnt(3)
  v_mfma_f32_32x32x16_bf16 v[16:31], v[84:87], v[52:55], v[16:31]
  s_add_u32 s55, s59, s57
  s_add_u32 s54, s57, 1024
  buffer_load_dwordx4 v[84:87], v14, s[32:35], s55 offen sc1
  s_cmp_eq_u32 s54, s98
  s_cselect_b32 s57, s99, s54
  ds_read_b128 v[52:55], v14 offset:9216
  s_waitcnt lgkmcnt(3)
  v_mfma_f32_32x32x16_bf16 v[16:31], v[88:91], v[56:59], v[16:31]
  s_add_u32 s55, s59, s57
  s_add_u32 s54, s57, 1024
  buffer_load_dwordx4 v[88:91], v14, s[32:35], s55 offen sc1
  s_cmp_eq_u32 s54, s98
  s_cselect_b32 s57, s99, s54
  ds_read_b128 v[56:59], v14 offset:10240
  s_waitcnt lgkmcnt(3)
  v_mfma_f32_32x32x16_bf16 v[16:31], v[92:95], v[60:63], v[16:31]
  s_add_u32 s55, s59, s57
  s_add_u32 s54, s57, 1024
  buffer_load_dwordx4 v[92:95], v14, s[32:35], s55 offen sc1
  s_cmp_eq_u32 s54, s98
  s_cselect_b32 s57, s99, s54
  ds_read_b128 v[60:63], v14 offset:11264
  s_waitcnt lgkmcnt(3)
  v_mfma_f32_32x32x16_bf16 v[16:31], v[96:99], v[48:51], v[16:31]
  s_add_u32 s55, s59, s57
  s_add_u32 s54, s57, 1024
  buffer_load_dwordx4 v[96:99], v14, s[32:35], s55 offen sc1
  s_cmp_eq_u32 s54, s98
  s_cselect_b32 s57, s99, s54
  ds_read_b128 v[48:51], v14 offset:12288
  s_waitcnt lgkmcnt(3)
  v_mfma_f32_32x32x16_bf16 v[16:31], v[100:103], v[52:55], v[16:31]
  s_add_u32 s55, s59, s57
  s_add_u32 s54, s57, 1024
  buffer_load_dwordx4 v[100:103], v14, s[32:35], s55 offen sc1
  s_cmp_eq_u32 s54, s98
  s_cselect_b32 s57, s99, s54
  ds_read_b128 v[52:55], v14 offset:13312
  s_waitcnt lgkmcnt(3)
  v_mfma_f32_32x32x16_bf16 v[16:31], v[104:107], v[56:59], v[16:31]
  s_add_u32 s55, s59, s57
  s_add_u32 s54, s57, 1024
  buffer_load_dwordx4 v[104:107], v14, s[32:35], s55 offen sc1
  s_cmp_eq_u32 s54, s98
  s_cselect_b32 s57, s99, s54
  ds_read_b128 v[56:59], v14 offset:14336
  s_waitcnt lgkmcnt(3)
  v_mfma_f32_32x32x16_bf16 v[16:31], v[108:111], v[60:63], v[16:31]
  s_add_u32 s55, s59, s57
  s_add_u32 s54, s57, 1024
  buffer_load_dwordx4 v[108:111], v14, s[32:35], s55 offen sc1
  s_cmp_eq_u32 s54, s98
  s_cselect_b32 s57, s99, s54
  ds_read_b128 v[60:63], v14 offset:15360
  s_waitcnt lgkmcnt(3)
  v_mfma_f32_32x32x16_bf16 v[16:31], v[112:115], v[48:51], v[16:31]
  s_add_u32 s55, s59, s57
  s_add_u32 s54, s57, 1024
  buffer_load_dwordx4 v[112:115], v14, s[32:35], s55 offen sc1
  s_cmp_eq_u32 s54, s98
  s_cselect_b32 s57, s99, s54
  ds_read_b128 v[48:51], v14 offset:16384
  s_waitcnt lgkmcnt(3)
  v_mfma_f32_32x32x16_bf16 v[16:31], v[116:119], v[52:55], v[16:31]
  s_add_u32 s55, s59, s57
  s_add_u32 s54, s57, 1024
  buffer_load_dwordx4 v[116:119], v14, s[32:35], s55 offen sc1
  s_cmp_eq_u32 s54, s98
  s_cselect_b32 s57, s99, s54
  ds_read_b128 v[52:55], v14 offset:17408
  s_waitcnt lgkmcnt(3)
  v_mfma_f32_32x32x16_bf16 v[16:31], v[120:123], v[56:59], v[16:31]
  s_add_u32 s55, s59, s57
  s_add_u32 s54, s57, 1024
  buffer_load_dwordx4 v[120:123], v14, s[32:35], s55 offen sc1
  s_cmp_eq_u32 s54, s98
  s_cselect_b32 s57, s99, s54
  ds_read_b128 v[56:59], v14 offset:18432
  s_waitcnt lgkmcnt(3)
  v_mfma_f32_32x32x16_bf16 v[16:31], v[124:127], v[60:63], v[16:31]
  s_add_u32 s55, s59, s57
  s_add_u32 s54, s57, 1024
  buffer_load_dwordx4 v[124:127], v14, s[32:35], s55 offen sc1
  s_cmp_eq_u32 s54, s98
  s_cselect_b32 s57, s99, s54
  ds_read_b128 v[60:63], v14 offset:19456
  s_waitcnt lgkmcnt(3)
  v_mfma_f32_32x32x16_bf16 v[16:31], v[32:35], v[48:51], v[16:31]
  s_add_u32 s55, s59, s57
  s_add_u32 s54, s57, 1024
  buffer_load_dwordx4 v[32:35], v14, s[32:35], s55 offen sc1
  s_cmp_eq_u32 s54, s98
  s_cselect_b32 s57, s99, s54
  ds_read_b128 v[48:51], v14 offset:20480
  s_waitcnt lgkmcnt(3)
  v_mfma_f32_32x32x16_bf16 v[16:31], v[36:39], v[52:55], v[16:31]
  s_add_u32 s55, s59, s57
  s_add_u32 s54, s57, 1024
  buffer_load_dwordx4 v[36:39], v14, s[32:35], s55 offen sc1
  s_cmp_eq_u32 s54, s98
  s_cselect_b32 s57, s99, s54
  ds_read_b128 v[52:55], v14 offset:21504
  s_waitcnt lgkmcnt(3)
  v_mfma_f32_32x32x16_bf16 v[16:31], v[40:43], v[56:59], v[16:31]
  s_add_u32 s55, s59, s57
  s_add_u32 s54, s57, 1024
  buffer_load_dwordx4 v[40:43], v14, s[32:35], s55 offen sc1
  s_cmp_eq_u32 s54, s98
  s_cselect_b32 s57, s99, s54
  ds_read_b128 v[56:59], v14 offset:22528
  s_waitcnt lgkmcnt(3)
  v_mfma_f32_32x32x16_bf16 v[16:31], v[44:47], v[60:63], v[16:31]
  s_add_u32 s55, s59, s57
  s_add_u32 s54, s57, 1024
  buffer_load_dwordx4 v[44:47], v14, s[32:35], s55 offen sc1
  s_cmp_eq_u32 s54, s98
  s_cselect_b32 s57, s99, s54
  ds_read_b128 v[60:63], v14 offset:23552
  s_waitcnt vmcnt(19)
  s_waitcnt lgkmcnt(3)
  v_mfma_f32_32x32x16_bf16 v[16:31], v[64:67], v[48:51], v[16:31]
  ds_read_b128 v[48:51], v14 offset:24576
  s_waitcnt vmcnt(18)
  s_waitcnt lgkmcnt(3)
  v_mfma_f32_32x32x16_bf16 v[16:31], v[68:71], v[52:55], v[16:31]
  ds_read_b128 v[52:55], v14 offset:25600
  s_waitcnt vmcnt(17)
  s_waitcnt lgkmcnt(3)
  v_mfma_f32_32x32x16_bf16 v[16:31], v[72:75], v[56:59], v[16:31]
  ds_read_b128 v[56:59], v14 offset:26624
  s_waitcnt vmcnt(16)
  s_waitcnt lgkmcnt(3)
  v_mfma_f32_32x32x16_bf16 v[16:31], v[76:79], v[60:63], v[16:31]
  ds_read_b128 v[60:63], v14 offset:27648
  s_waitcnt vmcnt(15)
  s_waitcnt lgkmcnt(3)
  v_mfma_f32_32x32x16_bf16 v[16:31], v[80:83], v[48:51], v[16:31]
  ds_read_b128 v[48:51], v14 offset:28672
  s_waitcnt vmcnt(14)
  s_waitcnt lgkmcnt(3)
  v_mfma_f32_32x32x16_bf16 v[16:31], v[84:87], v[52:55], v[16:31]
  ds_read_b128 v[52:55], v14 offset:29696
  s_waitcnt vmcnt(13)
  s_waitcnt lgkmcnt(3)
  v_mfma_f32_32x32x16_bf16 v[16:31], v[88:91], v[56:59], v[16:31]
  ds_read_b128 v[56:59], v14 offset:30720
  s_waitcnt vmcnt(12)
  s_waitcnt lgkmcnt(3)
  v_mfma_f32_32x32x16_bf16 v[16:31], v[92:95], v[60:63], v[16:31]
  ds_read_b128 v[60:63], v14 offset:31744
  s_waitcnt vmcnt(11)
  s_waitcnt lgkmcnt(3)
  v_mfma_f32_32x32x16_bf16 v[16:31], v[96:99], v[48:51], v[16:31]
  ds_read_b128 v[48:51], v14 offset:32768
  s_waitcnt vmcnt(10)
  s_waitcnt lgkmcnt(3)
  v_mfma_f32_32x32x16_bf16 v[16:31], v[100:103], v[52:55], v[16:31]
  ds_read_b128 v[52:55], v14 offset:33792
  s_waitcnt vmcnt(9)
  s_waitcnt lgkmcnt(3)
  v_mfma_f32_32x32x16_bf16 v[16:31], v[104:107], v[56:59], v[16:31]
  ds_read_b128 v[56:59], v14 offset:34816
  s_waitcnt vmcnt(8)
  s_waitcnt lgkmcnt(3)
  v_mfma_f32_32x32x16_bf16 v[16:31], v[108:111], v[60:63], v[16:31]
  ds_read_b128 v[60:63], v14 offset:35840
  s_waitcnt vmcnt(7)
  s_waitcnt lgkmcnt(3)
  v_mfma_f32_32x32x16_bf16 v[16:31], v[112:115], v[48:51], v[16:31]
  ds_read_b128 v[48:51], v14 offset:36864
  s_waitcnt vmcnt(6)
  s_waitcnt lgkmcnt(3)
  v_mfma_f32_32x32x16_bf16 v[16:31], v[116:119], v[52:55], v[16:31]
  ds_read_b128 v[52:55], v14 offset:37888
  s_waitcnt vmcnt(5)
  s_waitcnt lgkmcnt(3)
  v_mfma_f32_32x32x16_bf16 v[16:31], v[120:123], v[56:59], v[16:31]
  ds_read_b128 v[56:59], v14 offset:38912
  s_waitcnt vmcnt(4)
  s_waitcnt lgkmcnt(3)
  v_mfma_f32_32x32x16_bf16 v[16:31], v[124:127], v[60:63], v[16:31]
  ds_read_b128 v[60:63], v14 offset:39936
  s_waitcnt vmcnt(3)
  s_waitcnt lgkmcnt(3)
  v_mfma_f32_32x32x16_bf16 v[16:31], v[32:35], v[48:51], v[16:31]
  s_waitcnt vmcnt(2)
  s_waitcnt lgkmcnt(2)
  v_mfma_f32_32x32x16_bf16 v[16:31], v[36:39], v[52:55], v[16:31]
  s_waitcnt vmcnt(1)
  s_waitcnt lgkmcnt(1)
  v_mfma_f32_32x32x16_bf16 v[16:31], v[40:43], v[56:59], v[16:31]
  s_waitcnt vmcnt(0)
  s_waitcnt lgkmcnt(0)
  v_mfma_f32_32x32x16_bf16 v[16:31], v[44:47], v[60:63], v[16:31]
  s_setprio 3
  s_barrier
  s_nop 9
  s_mov_b32 s48, s24
  s_mov_b32 s49, s25
  s_mov_b32 s50, 2621440
  s_mov_b32 s51, 0x00020000
  v_cvt_pk_bf16_f32 v32, v16, v17
  v_cvt_pk_bf16_f32 v33, v18, v19
  buffer_store_dwordx2 v[32:33], v7, s[48:51], 0 offen offset:0
  v_cvt_pk_bf16_f32 v34, v20, v21
  v_cvt_pk_bf16_f32 v35, v22, v23
  buffer_store_dwordx2 v[34:35], v7, s[48:51], 0 offen offset:16
  v_cvt_pk_bf16_f32 v36, v24, v25
  v_cvt_pk_bf16_f32 v37, v26, v27
  buffer_store_dwordx2 v[36:37], v7, s[48:51], 0 offen offset:32
  v_cvt_pk_bf16_f32 v38, v28, v29
  v_cvt_pk_bf16_f32 v39, v30, v31
  buffer_store_dwordx2 v[38:39], v7, s[48:51], 0 offen offset:48
  s_barrier
  s_endpgm
B2_side2:
  ds_read_b128 v[48:51], v9 offset:0
  ds_read_b128 v[52:55], v9 offset:1024
  ds_read_b128 v[56:59], v9 offset:8192
  ds_read_b128 v[60:63], v9 offset:9216
  s_waitcnt lgkmcnt(3)
  v_mfma_f32_32x32x16_bf16 v[16:31], v[64:67], v[48:51], v[16:31]
  ds_read_b128 v[48:51], v9 offset:16384
  s_waitcnt lgkmcnt(3)
  v_mfma_f32_32x32x16_bf16 v[16:31], v[68:71], v[52:55], v[16:31]
  ds_read_b128 v[52:55], v9 offset:17408
  s_waitcnt lgkmcnt(3)
  v_mfma_f32_32x32x16_bf16 v[16:31], v[72:75], v[56:59], v[16:31]
  ds_read_b128 v[56:59], v9 offset:24576
  s_waitcnt lgkmcnt(3)
  v_mfma_f32_32x32x16_bf16 v[16:31], v[76:79], v[60:63], v[16:31]
  ds_read_b128 v[60:63], v9 offset:25600
  s_waitcnt lgkmcnt(3)
  v_mfma_f32_32x32x16_bf16 v[16:31], v[80:83], v[48:51], v[16:31]
  ds_read_b128 v[48:51], v9 offset:32768
  s_waitcnt lgkmcnt(3)
  v_mfma_f32_32x32x16_bf16 v[16:31], v[84:87], v[52:55], v[16:31]
  ds_read_b128 v[52:55], v9 offset:33792
  s_waitcnt lgkmcnt(3)
  v_mfma_f32_32x32x16_bf16 v[16:31], v[88:91], v[56:59], v[16:31]
  s_waitcnt lgkmcnt(2)
  v_mfma_f32_32x32x16_bf16 v[16:31], v[92:95], v[60:63], v[16:31]
  s_waitcnt lgkmcnt(1)
  v_mfma_f32_32x32x16_bf16 v[16:31], v[96:99], v[48:51], v[16:31]
  s_waitcnt lgkmcnt(0)
  v_mfma_f32_32x32x16_bf16 v[16:31], v[100:103], v[52:55], v[16:31]
  s_setprio 3
  s_barrier
  s_nop 11
  s_sub_u32 s56, s30, 4
  s_lshl_b32 s54, s56, 12
  v_add_u32 v4, s54, v14
  ds_write_b128 v4, v[16:19] offset:0
  ds_write_b128 v4, v[20:23] offset:1024
  ds_write_b128 v4, v[24:27] offset:2048
  ds_write_b128 v4, v[28:31] offset:3072
  s_waitcnt lgkmcnt(0)
  s_barrier
  s_lshl_b32 s54, s56, 10
  v_add_u32 v4, s54, v14
  ds_read_b128 v[16:19], v4 offset:0
  ds_read_b128 v[20:23], v4 offset:4096
  ds_read_b128 v[24:27], v4 offset:8192
  ds_read_b128 v[28:31], v4 offset:12288
  s_lshl_b32 s54, s56, 4
  v_add_u32 v7, s54, v7
  s_mov_b32 s48, s24
  s_mov_b32 s49, s25
  s_mov_b32 s50, 2621440
  s_mov_b32 s51, 0x00020000
  s_waitcnt lgkmcnt(0)
  v_add_f32 v16, v16, v20
  v_add_f32 v24, v24, v28
  v_add_f32 v17, v17, v21
  v_add_f32 v25, v25, v29
  v_add_f32 v18, v18, v22
  v_add_f32 v26, v26, v30
  v_add_f32 v19, v19, v23
  v_add_f32 v27, v27, v31
  v_add_f32 v16, v16, v40
  v_add_f32 v17, v17, v41
  v_add_f32 v18, v18, v42
  v_add_f32 v19, v19, v43
  v_add_f32 v16, v16, v24
  v_add_f32 v17, v17, v25
  v_add_f32 v18, v18, v26
  v_add_f32 v19, v19, v27
  v_cvt_pk_bf16_f32 v32, v16, v17
  v_cvt_pk_bf16_f32 v33, v18, v19
  buffer_store_dwordx2 v[32:33], v7, s[48:51], 0 offen
  s_endpgm
K_end:
  s_endpgm
.section .rodata,"a"
.p2align 6
.amdhsa_kernel parallel_sum__grouped_kv_mqa__dense_activation_squared_relu__prompt_kernel
  .amdhsa_next_free_vgpr 128
  .amdhsa_next_free_sgpr 102
  .amdhsa_accum_offset 128
  .amdhsa_group_segment_fixed_size 0
  .amdhsa_kernarg_size 104
  .amdhsa_user_sgpr_count 2
  .amdhsa_user_sgpr_kernarg_segment_ptr 1
  .amdhsa_system_sgpr_workgroup_id_x 1
.end_amdhsa_kernel
```
